```python
import torch

def _softmax(x, axis=-1):
    return torch.softmax(x, dim=axis)
def _gelu(x):
    return torch.nn.functional.gelu(x, approximate="tanh")
def _silu(x):
    return torch.nn.functional.silu(x)
def _sigmoid(x):
    return torch.sigmoid(x)
def _layernorm(x, axis=-1, eps=1e-5):
    m = x.mean(dim=axis, keepdim=True)
    v = x.var(dim=axis, keepdim=True, unbiased=False)
    return (x - m) / torch.sqrt(v + eps)
def _scatter_add(tgt, idx, src, axis=0):
    return tgt.clone().index_add_(axis, idx, src)
def _segment_sum(src, seg, n):
    out = torch.zeros((n,) + src.shape[1:], dtype=src.dtype)
    return out.index_add_(0, seg, src)
def _pad(x, pw):
    flat = tuple(v for pair in reversed(pw) for v in pair)
    return torch.nn.functional.pad(x, flat)

kernel_name = 'sequential_preLN__gqa_block_cached__glu_gated_geglu__decode'

def setup_inputs():

    _w = (lambda a: (lambda t: t.to(torch.bfloat16) if t.is_floating_point() else t)(torch.as_tensor(a)))
    def _A_setup():
        B, Sq, D = 1, 1, 512
        Hq, Hkv, Sk, Dh = 32, 8, 65536, 128
        assert Hq % Hkv == 0, (Hq, Hkv)
        return {
            "x": _w((lambda *s: torch.randn(*s, dtype=torch.bfloat16) * 0.05)(B, Sq, D)),
            "k_cache": _w((lambda *s: torch.randn(*s, dtype=torch.bfloat16) * 1.6)(B, Hkv, Sk, Dh)),
            "v_cache": _w((lambda *s: torch.randn(*s, dtype=torch.bfloat16) * 1.6)(B, Hkv, Sk, Dh)),
            "wq": _w((lambda *s: torch.randn(*s, dtype=torch.bfloat16) * 1.6)(D, Hq * Dh) * (D ** -0.5)),
            "wo": _w((lambda *s: torch.randn(*s, dtype=torch.bfloat16) * 1.6)(Hq * Dh, D) * ((Hq * Dh) ** -0.5)),
        }
    _A_in = _A_setup()

    def _B_setup():
        B, S, Dm, Df = 1, 1, 512, 1792
        return {
            "x": _w((lambda *s: torch.randn(*s, dtype=torch.bfloat16) * 0.05)(B, S, Dm)),
            "w_gate": _w((lambda *s: torch.randn(*s, dtype=torch.bfloat16) * 0.8)(Dm, Df) * (Dm ** -0.5)),
            "w_up": _w((lambda *s: torch.randn(*s, dtype=torch.bfloat16) * 0.8)(Dm, Df) * (Dm ** -0.5)),
            "w_down": _w((lambda *s: torch.randn(*s, dtype=torch.bfloat16) * 0.8)(Df, Dm) * (Df ** -0.5)),
        }
    _B_in = _B_setup()

    return {
        "A_x": _A_in["x"],
        "A_k_cache": _A_in["k_cache"],
        "A_v_cache": _A_in["v_cache"],
        "A_wq": _A_in["wq"],
        "A_wo": _A_in["wo"],
        "B_x": _B_in["x"],
        "B_w_gate": _B_in["w_gate"],
        "B_w_up": _B_in["w_up"],
        "B_w_down": _B_in["w_down"],
    }

def reference(A_x, A_k_cache, A_v_cache, A_wq, A_wo, B_x, B_w_gate, B_w_up, B_w_down):
    def _A_ref(x, k_cache, v_cache, wq, wo):
        B, Sq, D = x.shape
        Hq, Dh = 32, 128
        Hkv = k_cache.shape[1]
        rep = Hq // Hkv
        q = (lambda x, *d: x.permute(*d))((x @ wq).reshape(B, Sq, Hq, Dh), 0, 2, 1, 3)
        k = (lambda x, n, axis: torch.repeat_interleave(x, n, dim=axis))(k_cache, rep, axis=1)
        v = (lambda x, n, axis: torch.repeat_interleave(x, n, dim=axis))(v_cache, rep, axis=1)
        scores = torch.einsum("bhqd,bhkd->bhqk", q, k) * (Dh ** -0.5)
        p = _softmax(scores, axis=-1)
        o = torch.einsum("bhqk,bhkd->bhqd", p, v)
        return (lambda x, *d: x.permute(*d))(o, 0, 2, 1, 3).reshape(B, Sq, Hq * Dh) @ wo

    def _B_ref(x, w_gate, w_up, w_down):
        g = torch.einsum("bsd,df->bsf", x, w_gate)
        u = torch.einsum("bsd,df->bsf", x, w_up)
        h = _gelu(g) * u
        return torch.einsum("bsf,fd->bsd", h, w_down)

    x = A_x
    h = x + _A_ref(_layernorm(x, axis=-1), A_k_cache, A_v_cache, A_wq, A_wo)
    h2 = h + _B_ref(_layernorm(h, axis=-1), B_w_gate, B_w_up, B_w_down)
    return h2
```

```asm
; @launch grid=(256,1,1) block=(384,1,1) lds=163840
.amdgcn_target "amdgcn-amd-amdhsa--gfx950"
.text
.globl sequential_preLN__gqa_block_cached__glu_gated_geglu__decode_kernel
.p2align 8
.type sequential_preLN__gqa_block_cached__glu_gated_geglu__decode_kernel,@function
sequential_preLN__gqa_block_cached__glu_gated_geglu__decode_kernel:
    s_cmp_ge_u32 s2, 256
    s_cbranch_scc1 L_end
    s_load_dwordx16 s[36:51], s[0:1], 0
    s_load_dwordx8 s[52:59], s[0:1], 64
    v_lshrrev_b32 v1, 6, v0
    v_and_b32 v0, 63, v0
    v_readfirstlane_b32 s3, v1
    s_and_b32 s7, s2, 7
    s_lshr_b32 s4, s2, 3
    s_and_b32 s4, s4, 7
    s_lshr_b32 s6, s2, 6
    s_lshl_b32 s5, s7, 2
    s_add_u32 s5, s5, s6
    s_and_b32 s61, s6, 1
    s_mov_b32 s62, s7
    s_cmp_lt_u32 s6, 2
    s_cselect_b32 s67, 1, 0
    s_lshr_b32 s63, s2, 3
    s_sub_u32 s63, s63, 16
    s_lshr_b32 s64, s63, 2
    s_lshl_b32 s64, s64, 3
    s_add_u32 s64, s64, s7
    s_and_b32 s65, s63, 3
    s_lshl_b32 s66, s64, 2
    s_add_u32 s65, s65, s66
    s_cmp_lt_u32 s64, 28
    s_cselect_b32 s63, s65, -1
    s_cmp_eq_u32 s67, 1
    s_cselect_b32 s63, -1, s63
    s_lshl_b32 s6, s4, 5
    s_add_u32 s6, s6, s5
    v_and_b32 v1, 15, v0
    v_lshrrev_b32 v4, 4, v0
    s_lshl_b32 s64, s4, 1
    s_add_u32 s64, s64, s61
    s_lshl_b32 s64, s64, 11
    s_lshl_b32 s65, s62, 8
    s_add_u32 s64, s64, s65
    s_cmp_eq_u32 s3, 1
    s_cbranch_scc1 L_helper
    s_cmp_ge_u32 s3, 2
    s_cbranch_scc1 L_consumer
    s_setprio 3
    v_lshlrev_b32 v5, 8, v4
    v_add_u32 v6, 0, v4
    v_xor_b32 v6, v6, v1
    v_lshl_add_u32 v10, v6, 4, v5
    v_add_u32 v6, 4, v4
    v_xor_b32 v6, v6, v1
    v_lshl_add_u32 v11, v6, 4, v5
    v_add_u32 v6, 8, v4
    v_xor_b32 v6, v6, v1
    v_lshl_add_u32 v12, v6, 4, v5
    v_add_u32 v6, 12, v4
    v_xor_b32 v6, v6, v1
    v_lshl_add_u32 v13, v6, 4, v5
    v_add_u32 v6, 0, v4
    v_lshlrev_b32 v6, 1, v6
    v_xor_b32 v6, v6, v1
    v_lshl_add_u32 v14, v6, 4, v5
    v_add_u32 v6, 4, v4
    v_lshlrev_b32 v6, 1, v6
    v_xor_b32 v6, v6, v1
    v_lshl_add_u32 v15, v6, 4, v5
    v_lshlrev_b32 v16, 2, v0
    v_add_u32 v16, 155904, v16
    v_mov_b32 v5, 155648
    v_cmp_eq_u32 vcc, 0, v0
    v_mov_b32 v6, 155724
    s_mov_b32 s22, 0
    v_cndmask_b32 v20, v16, v6, vcc
    v_cndmask_b32 v16, v16, v5, vcc
    s_lshl_b32 s20, s5, 19
    s_lshl_b32 s31, s22, 13
    s_add_u32 s20, s20, s31
    s_lshl_b32 s31, s4, 24
    s_add_u32 s20, s20, s31
    s_mov_b32 s21, 0
    s_waitcnt lgkmcnt(0)
    s_mov_b32 s8, s38
    s_and_b32 s9, s39, 0xffff
    s_mov_b32 s10, 0x8000000
    s_mov_b32 s11, 0x20000
    s_mov_b32 s12, s40
    s_and_b32 s13, s41, 0xffff
    s_mov_b32 s14, 0x8000000
    s_mov_b32 s15, 0x20000
    s_add_u32 m0, s21, 0
    s_add_u32 s23, s20, 0
    s_waitcnt vmcnt(19)
    buffer_load_dwordx4 v10, s[8:11], s23 offen offset:0 nt lds
    s_waitcnt vmcnt(19)
    buffer_load_dwordx4 v11, s[8:11], s23 offen offset:1024 nt lds
    s_waitcnt vmcnt(19)
    buffer_load_dwordx4 v12, s[8:11], s23 offen offset:2048 nt lds
    s_waitcnt vmcnt(19)
    buffer_load_dwordx4 v13, s[8:11], s23 offen offset:3072 nt lds
    s_add_u32 m0, s21, 4096
    s_add_u32 s23, s20, 4096
    s_waitcnt vmcnt(19)
    buffer_load_dwordx4 v10, s[8:11], s23 offen offset:0 nt lds
    s_waitcnt vmcnt(19)
    buffer_load_dwordx4 v11, s[8:11], s23 offen offset:1024 nt lds
    s_waitcnt vmcnt(19)
    buffer_load_dwordx4 v12, s[8:11], s23 offen offset:2048 nt lds
    s_waitcnt vmcnt(19)
    buffer_load_dwordx4 v13, s[8:11], s23 offen offset:3072 nt lds
    s_add_u32 m0, s21, 8192
    s_add_u32 s23, s20, 0
    s_waitcnt vmcnt(19)
    buffer_load_dwordx4 v14, s[12:15], s23 offen offset:0 nt lds
    s_waitcnt vmcnt(19)
    buffer_load_dwordx4 v15, s[12:15], s23 offen offset:1024 nt lds
    s_waitcnt vmcnt(19)
    buffer_load_dwordx4 v14, s[12:15], s23 offen offset:2048 nt lds
    s_waitcnt vmcnt(19)
    buffer_load_dwordx4 v15, s[12:15], s23 offen offset:3072 nt lds
    s_add_u32 m0, s21, 12288
    s_add_u32 s23, s20, 4096
    s_waitcnt vmcnt(19)
    buffer_load_dwordx4 v14, s[12:15], s23 offen offset:0 nt lds
    s_waitcnt vmcnt(19)
    buffer_load_dwordx4 v15, s[12:15], s23 offen offset:1024 nt lds
    s_waitcnt vmcnt(19)
    buffer_load_dwordx4 v14, s[12:15], s23 offen offset:2048 nt lds
    s_waitcnt vmcnt(19)
    buffer_load_dwordx4 v15, s[12:15], s23 offen offset:3072 nt lds
    s_mov_b32 s34, -1
    s_mov_b32 s35, 0
    s_mov_b32 s33, -1
    s_mov_b32 s32, 0
    v_lshrrev_b32 v2, 2, v0
    v_and_b32 v3, 3, v0
    v_lshlrev_b32 v21, 10, v2
    v_lshl_add_u32 v21, v3, 4, v21
    v_mul_u32_u24 v22, 3584, v0
    v_lshlrev_b32 v23, 4, v0
    v_mov_b32 v26, 155732
    v_mov_b32 v27, 155760
    v_mov_b32 v28, 0
    v_mov_b32 v29, 0
    s_barrier
    s_mov_b32 s25, 16384
    v_mov_b32 v19, 155668
    ds_read_b32 v18, v19
    s_add_u32 s22, s22, 1
    s_mov_b32 s21, s25
    s_lshl_b32 s20, s5, 19
    s_lshl_b32 s31, s22, 13
    s_add_u32 s20, s20, s31
    s_lshl_b32 s31, s4, 24
    s_add_u32 s20, s20, s31
L_kvloop:
L_wret:
    s_mov_b32 s27, 4194304
    s_waitcnt lgkmcnt(0)
L_fr_1:
    v_readfirstlane_b32 s26, v18
    s_cmp_ge_i32 s26, s22
    s_cbranch_scc1 L_frx_2
    ds_read_b32 v18, v19
    s_sub_u32 s27, s27, 1
    s_cmp_lg_u32 s27, 0
    s_waitcnt lgkmcnt(0)
    s_cbranch_scc1 L_fr_1
    s_branch L_end
L_frx_2:
    s_cmp_lt_u32 s22, 60
    s_cbranch_scc1 L_static
    s_sub_u32 s28, s22, 60
    s_mov_b32 s27, 4194304
L_tkspin:
    v_readfirstlane_b32 s26, v28
    v_readfirstlane_b32 s29, v29
    s_cmp_gt_i32 s26, s28
    s_cbranch_scc1 L_tkgot
    ds_read_b32 v28, v26
    s_waitcnt lgkmcnt(0)
    ds_read_b32 v29, v27
    s_sub_u32 s27, s27, 1
    s_cmp_lg_u32 s27, 0
    s_waitcnt lgkmcnt(0)
    s_cbranch_scc1 L_tkspin
    s_branch L_end
L_tkgot:
    s_cmp_ge_u32 s29, 32
    s_cbranch_scc1 L_kvdone
    s_and_b32 s20, s29, 7
    s_lshl_b32 s20, s20, 2
    s_and_b32 s31, s5, 3
    s_add_u32 s20, s20, s31
    s_lshl_b32 s20, s20, 19
    s_lshr_b32 s31, s29, 3
    s_add_u32 s31, s31, 60
    s_lshl_b32 s31, s31, 13
    s_add_u32 s20, s20, s31
    s_lshl_b32 s31, s4, 24
    s_add_u32 s20, s20, s31
L_static:
    s_add_u32 m0, s21, 0
    s_add_u32 s23, s20, 0
    s_waitcnt vmcnt(19)
    buffer_load_dwordx4 v10, s[8:11], s23 offen offset:0 nt lds
    s_waitcnt vmcnt(19)
    buffer_load_dwordx4 v11, s[8:11], s23 offen offset:1024 nt lds
    s_waitcnt vmcnt(19)
    buffer_load_dwordx4 v12, s[8:11], s23 offen offset:2048 nt lds
    s_waitcnt vmcnt(19)
    s_lshl_b32 s24, s22, 1
    s_add_i32 s24, s24, -2
    v_mov_b32 v17, s24
    ds_write_b32 v16, v17
    buffer_load_dwordx4 v13, s[8:11], s23 offen offset:3072 nt lds
    s_add_u32 m0, s21, 4096
    s_add_u32 s23, s20, 4096
    s_waitcnt vmcnt(19)
    buffer_load_dwordx4 v10, s[8:11], s23 offen offset:0 nt lds
    s_waitcnt vmcnt(19)
    buffer_load_dwordx4 v11, s[8:11], s23 offen offset:1024 nt lds
    s_waitcnt vmcnt(19)
    buffer_load_dwordx4 v12, s[8:11], s23 offen offset:2048 nt lds
    s_waitcnt vmcnt(19)
    buffer_load_dwordx4 v13, s[8:11], s23 offen offset:3072 nt lds
    s_add_u32 s25, s21, 16384
    s_cmp_ge_u32 s25, 98304
    s_cselect_b32 s25, 0, s25
    s_lshr_b32 s26, s25, 12
    s_add_u32 s26, s26, 155664
    v_mov_b32 v19, s26
    ds_read_b32 v18, v19
    s_add_u32 m0, s21, 8192
    s_add_u32 s23, s20, 0
    s_waitcnt vmcnt(19)
    buffer_load_dwordx4 v14, s[12:15], s23 offen offset:0 nt lds
    s_waitcnt vmcnt(19)
    buffer_load_dwordx4 v15, s[12:15], s23 offen offset:1024 nt lds
    s_waitcnt vmcnt(19)
    buffer_load_dwordx4 v14, s[12:15], s23 offen offset:2048 nt lds
    s_waitcnt vmcnt(19)
    s_lshl_b32 s24, s22, 1
    s_add_i32 s24, s24, -1
    v_mov_b32 v17, s24
    ds_write_b32 v16, v17
    buffer_load_dwordx4 v15, s[12:15], s23 offen offset:3072 nt lds
    s_add_u32 s26, s22, -59
    s_and_b32 s26, s26, 3
    s_lshl_b32 s26, s26, 2
    s_add_u32 s26, s26, 155760
    v_mov_b32 v27, s26
    ds_read_b32 v28, v26
    ds_read_b32 v29, v27
    s_add_u32 m0, s21, 12288
    s_add_u32 s23, s20, 4096
    s_waitcnt vmcnt(19)
    buffer_load_dwordx4 v14, s[12:15], s23 offen offset:0 nt lds
    s_waitcnt vmcnt(19)
    buffer_load_dwordx4 v15, s[12:15], s23 offen offset:1024 nt lds
    s_waitcnt vmcnt(19)
    buffer_load_dwordx4 v14, s[12:15], s23 offen offset:2048 nt lds
    s_waitcnt vmcnt(19)
    buffer_load_dwordx4 v15, s[12:15], s23 offen offset:3072 nt lds
    s_add_u32 s22, s22, 1
    s_mov_b32 s21, s25
    s_lshl_b32 s20, s5, 19
    s_lshl_b32 s31, s22, 13
    s_add_u32 s20, s20, s31
    s_lshl_b32 s31, s4, 24
    s_add_u32 s20, s20, s31
    s_branch L_kvloop
L_kvdone:
    s_waitcnt lgkmcnt(0)
    v_mov_b32 v17, s22
    v_mov_b32 v30, 155652
    s_mov_b64 exec, 1
    ds_write_b32 v30, v17
    s_mov_b64 exec, -1
    s_lshl_b32 s24, s22, 1
    s_add_i32 s24, s24, -2
    s_waitcnt vmcnt(16)
    v_mov_b32 v17, s24
    ds_write_b32 v16, v17
    s_lshl_b32 s24, s22, 1
    s_add_i32 s24, s24, -1
    s_waitcnt vmcnt(8)
    v_mov_b32 v17, s24
    ds_write_b32 v16, v17
    s_lshl_b32 s24, s22, 1
    s_add_i32 s24, s24, 0
    s_waitcnt vmcnt(0)
    v_mov_b32 v17, s24
    ds_write_b32 v16, v17
    s_waitcnt lgkmcnt(0)
    s_endpgm
L_helper:
    v_lshlrev_b32 v5, 4, v0
    v_lshrrev_b32 v6, 1, v0
    v_and_b32 v7, 1, v0
    v_lshlrev_b32 v6, 13, v6
    v_lshl_add_u32 v6, v7, 4, v6
    s_lshl_b32 s20, s6, 5
    s_waitcnt lgkmcnt(0)
    s_mov_b32 s12, s36
    s_and_b32 s13, s37, 0xffff
    s_mov_b32 s14, 0x400
    s_mov_b32 s15, 0x20000
    s_mov_b32 s16, s42
    s_and_b32 s17, s43, 0xffff
    s_mov_b32 s18, 0x400000
    s_mov_b32 s19, 0x20000
    buffer_load_dwordx4 v[8:11], v5, s[12:15], 0 offen
    s_mov_b32 m0, 114688
    s_nop 0
    buffer_load_dwordx4 v6, s[16:19], s20 offen  lds
    s_mov_b32 m0, 115712
    s_add_u32 s20, s20, 262144
    buffer_load_dwordx4 v6, s[16:19], s20 offen  lds
    s_mov_b32 m0, 116736
    s_add_u32 s20, s20, 262144
    buffer_load_dwordx4 v6, s[16:19], s20 offen  lds
    s_mov_b32 m0, 117760
    s_add_u32 s20, s20, 262144
    buffer_load_dwordx4 v6, s[16:19], s20 offen  lds
    s_mov_b32 m0, 118784
    s_add_u32 s20, s20, 262144
    buffer_load_dwordx4 v6, s[16:19], s20 offen  lds
    s_mov_b32 m0, 119808
    s_add_u32 s20, s20, 262144
    buffer_load_dwordx4 v6, s[16:19], s20 offen  lds
    s_mov_b32 m0, 120832
    s_add_u32 s20, s20, 262144
    buffer_load_dwordx4 v6, s[16:19], s20 offen  lds
    s_mov_b32 m0, 121856
    s_add_u32 s20, s20, 262144
    buffer_load_dwordx4 v6, s[16:19], s20 offen  lds
    s_mov_b32 m0, 122880
    s_add_u32 s20, s20, 262144
    buffer_load_dwordx4 v6, s[16:19], s20 offen  lds
    s_mov_b32 m0, 123904
    s_add_u32 s20, s20, 262144
    buffer_load_dwordx4 v6, s[16:19], s20 offen  lds
    s_mov_b32 m0, 124928
    s_add_u32 s20, s20, 262144
    buffer_load_dwordx4 v6, s[16:19], s20 offen  lds
    s_mov_b32 m0, 125952
    s_add_u32 s20, s20, 262144
    buffer_load_dwordx4 v6, s[16:19], s20 offen  lds
    s_mov_b32 m0, 126976
    s_add_u32 s20, s20, 262144
    buffer_load_dwordx4 v6, s[16:19], s20 offen  lds
    s_mov_b32 m0, 128000
    s_add_u32 s20, s20, 262144
    buffer_load_dwordx4 v6, s[16:19], s20 offen  lds
    s_mov_b32 m0, 129024
    s_add_u32 s20, s20, 262144
    buffer_load_dwordx4 v6, s[16:19], s20 offen  lds
    s_mov_b32 m0, 130048
    s_add_u32 s20, s20, 262144
    buffer_load_dwordx4 v6, s[16:19], s20 offen  lds
    s_load_dword s60, s[58:59], 0
    s_mov_b32 s8, s58
    s_and_b32 s9, s59, 0xffff
    s_mov_b32 s10, 0x200000
    s_mov_b32 s11, 0x20000
    s_barrier
    s_waitcnt vmcnt(16)
    v_lshlrev_b32 v16, 16, v8
    v_and_b32 v17, 0xffff0000, v8
    v_lshlrev_b32 v18, 16, v9
    v_and_b32 v19, 0xffff0000, v9
    v_lshlrev_b32 v20, 16, v10
    v_and_b32 v21, 0xffff0000, v10
    v_lshlrev_b32 v22, 16, v11
    v_and_b32 v23, 0xffff0000, v11
    v_readfirstlane_b32 s22, v16
    s_nop 1
    v_subrev_f32 v28, s22, v16
    v_subrev_f32 v29, s22, v17
    v_subrev_f32 v30, s22, v18
    v_subrev_f32 v31, s22, v19
    v_subrev_f32 v32, s22, v20
    v_subrev_f32 v33, s22, v21
    v_subrev_f32 v34, s22, v22
    v_subrev_f32 v35, s22, v23
    v_add_f32 v24, v28, v29
    v_mul_f32 v25, v28, v28
    v_fmac_f32 v25, v29, v29
    v_add_f32 v24, v24, v30
    v_fmac_f32 v25, v30, v30
    v_add_f32 v24, v24, v31
    v_fmac_f32 v25, v31, v31
    v_add_f32 v24, v24, v32
    v_fmac_f32 v25, v32, v32
    v_add_f32 v24, v24, v33
    v_fmac_f32 v25, v33, v33
    v_add_f32 v24, v24, v34
    v_fmac_f32 v25, v34, v34
    v_add_f32 v24, v24, v35
    v_fmac_f32 v25, v35, v35
    s_nop 0
    v_add_f32_dpp v24, v24, v24 row_ror:8 row_mask:0xf bank_mask:0xf
    v_add_f32_dpp v25, v25, v25 row_ror:8 row_mask:0xf bank_mask:0xf
    s_nop 0
    v_add_f32_dpp v24, v24, v24 row_ror:4 row_mask:0xf bank_mask:0xf
    v_add_f32_dpp v25, v25, v25 row_ror:4 row_mask:0xf bank_mask:0xf
    s_nop 0
    v_add_f32_dpp v24, v24, v24 row_ror:2 row_mask:0xf bank_mask:0xf
    v_add_f32_dpp v25, v25, v25 row_ror:2 row_mask:0xf bank_mask:0xf
    s_nop 0
    v_add_f32_dpp v24, v24, v24 row_ror:1 row_mask:0xf bank_mask:0xf
    v_add_f32_dpp v25, v25, v25 row_ror:1 row_mask:0xf bank_mask:0xf
    s_nop 0
    v_add_f32_dpp v24, v24, v24 row_bcast:15 row_mask:0xa bank_mask:0xf
    v_add_f32_dpp v25, v25, v25 row_bcast:15 row_mask:0xa bank_mask:0xf
    s_nop 0
    v_add_f32_dpp v24, v24, v24 row_bcast:31 row_mask:0xc bank_mask:0xf
    v_add_f32_dpp v25, v25, v25 row_bcast:31 row_mask:0xc bank_mask:0xf
    s_nop 0
    v_readlane_b32 s23, v24, 63
    v_readlane_b32 s24, v25, 63
    s_mov_b32 s25, 0x3b000000
    s_nop 0
    v_mov_b32 v24, s23
    v_mov_b32 v25, s24
    v_mul_f32 v24, s25, v24
    v_mul_f32 v25, s25, v25
    v_fma_f32 v25, -v24, v24, v25
    v_add_f32 v24, s22, v24
    v_max_f32 v25, 0, v25
    v_cvt_pk_bf16_f32 v25, v25, v24
    v_and_b32 v26, 0xffff0000, v25
    v_lshlrev_b32 v25, 16, v25
    v_add_f32 v25, 0x3727c5ac, v25
    v_cvt_pk_bf16_f32 v25, v25, v25
    v_lshlrev_b32 v25, 16, v25
    v_sqrt_f32 v25, v25
    s_nop 0
    v_cvt_pk_bf16_f32 v25, v25, v25
    v_lshlrev_b32 v25, 16, v25
    v_rcp_f32 v24, v25
    s_nop 0
    v_fma_f32 v27, -v25, v24, 1.0
    v_fma_f32 v24, v24, v27, v24
    v_sub_f32 v28, v16, v26
    v_sub_f32 v29, v17, v26
    v_sub_f32 v30, v18, v26
    v_sub_f32 v31, v19, v26
    v_sub_f32 v32, v20, v26
    v_sub_f32 v33, v21, v26
    v_sub_f32 v34, v22, v26
    v_sub_f32 v35, v23, v26
    v_cvt_pk_bf16_f32 v40, v28, v29
    v_cvt_pk_bf16_f32 v41, v30, v31
    v_cvt_pk_bf16_f32 v42, v32, v33
    v_cvt_pk_bf16_f32 v43, v34, v35
    v_lshlrev_b32 v28, 16, v40
    v_and_b32 v29, 0xffff0000, v40
    v_lshlrev_b32 v30, 16, v41
    v_and_b32 v31, 0xffff0000, v41
    v_lshlrev_b32 v32, 16, v42
    v_and_b32 v33, 0xffff0000, v42
    v_lshlrev_b32 v34, 16, v43
    v_and_b32 v35, 0xffff0000, v43
    v_mul_f32 v28, v28, v24
    v_mul_f32 v29, v29, v24
    v_mul_f32 v30, v30, v24
    v_mul_f32 v31, v31, v24
    v_mul_f32 v32, v32, v24
    v_mul_f32 v33, v33, v24
    v_mul_f32 v34, v34, v24
    v_mul_f32 v35, v35, v24
    v_cvt_pk_bf16_f32 v40, v28, v29
    v_cvt_pk_bf16_f32 v41, v30, v31
    v_cvt_pk_bf16_f32 v42, v32, v33
    v_cvt_pk_bf16_f32 v43, v34, v35
    v_lshlrev_b32 v5, 4, v0
    v_add_u32 v5, 156160, v5
    ds_write_b128 v5, v[40:43]
    v_bfe_u32 v6, v0, 2, 2
    v_lshl_add_u32 v6, v4, 3, v6
    v_lshlrev_b32 v6, 5, v6
    v_and_b32 v7, 3, v0
    v_lshl_add_u32 v6, v7, 3, v6
    v_add_u32 v6, 114688, v6
    v_lshlrev_b32 v7, 4, v4
    v_add_u32 v7, 156160, v7
    s_waitcnt lgkmcnt(0)
    ds_read_b128 v[64:67], v7 offset:0
    ds_read_b128 v[68:71], v7 offset:64
    ds_read_b128 v[72:75], v7 offset:128
    ds_read_b128 v[76:79], v7 offset:192
    ds_read_b128 v[80:83], v7 offset:256
    ds_read_b128 v[84:87], v7 offset:320
    ds_read_b128 v[88:91], v7 offset:384
    ds_read_b128 v[92:95], v7 offset:448
    s_waitcnt lgkmcnt(4)
    ds_read_b128 v[96:99], v7 offset:512
    ds_read_b128 v[100:103], v7 offset:576
    ds_read_b128 v[104:107], v7 offset:640
    ds_read_b128 v[108:111], v7 offset:704
    ds_read_b128 v[112:115], v7 offset:768
    ds_read_b128 v[116:119], v7 offset:832
    ds_read_b128 v[120:123], v7 offset:896
    ds_read_b128 v[124:127], v7 offset:960
    s_waitcnt vmcnt(0) lgkmcnt(0)
    ds_read_b64_tr_b16 v[128:129], v6 offset:0
    ds_read_b64_tr_b16 v[130:131], v6 offset:128
    ds_read_b64_tr_b16 v[132:133], v6 offset:1024
    ds_read_b64_tr_b16 v[134:135], v6 offset:1152
    ds_read_b64_tr_b16 v[136:137], v6 offset:2048
    ds_read_b64_tr_b16 v[138:139], v6 offset:2176
    ds_read_b64_tr_b16 v[140:141], v6 offset:3072
    ds_read_b64_tr_b16 v[142:143], v6 offset:3200
    ds_read_b64_tr_b16 v[144:145], v6 offset:4096
    ds_read_b64_tr_b16 v[146:147], v6 offset:4224
    ds_read_b64_tr_b16 v[148:149], v6 offset:5120
    ds_read_b64_tr_b16 v[150:151], v6 offset:5248
    ds_read_b64_tr_b16 v[152:153], v6 offset:6144
    ds_read_b64_tr_b16 v[154:155], v6 offset:6272
    ds_read_b64_tr_b16 v[156:157], v6 offset:7168
    ds_read_b64_tr_b16 v[158:159], v6 offset:7296
    s_waitcnt lgkmcnt(8)
    v_mfma_f32_16x16x32_bf16 v[44:47], v[128:131], v[64:67], 0
    v_mfma_f32_16x16x32_bf16 v[48:51], v[132:135], v[68:71], 0
    v_mfma_f32_16x16x32_bf16 v[44:47], v[136:139], v[72:75], v[44:47]
    v_mfma_f32_16x16x32_bf16 v[48:51], v[140:143], v[76:79], v[48:51]
    ds_read_b64_tr_b16 v[128:129], v6 offset:8192
    ds_read_b64_tr_b16 v[130:131], v6 offset:8320
    ds_read_b64_tr_b16 v[132:133], v6 offset:9216
    ds_read_b64_tr_b16 v[134:135], v6 offset:9344
    ds_read_b64_tr_b16 v[136:137], v6 offset:10240
    ds_read_b64_tr_b16 v[138:139], v6 offset:10368
    ds_read_b64_tr_b16 v[140:141], v6 offset:11264
    ds_read_b64_tr_b16 v[142:143], v6 offset:11392
    s_waitcnt lgkmcnt(8)
    v_mfma_f32_16x16x32_bf16 v[44:47], v[144:147], v[80:83], v[44:47]
    v_mfma_f32_16x16x32_bf16 v[48:51], v[148:151], v[84:87], v[48:51]
    v_mfma_f32_16x16x32_bf16 v[44:47], v[152:155], v[88:91], v[44:47]
    v_mfma_f32_16x16x32_bf16 v[48:51], v[156:159], v[92:95], v[48:51]
    ds_read_b64_tr_b16 v[144:145], v6 offset:12288
    ds_read_b64_tr_b16 v[146:147], v6 offset:12416
    ds_read_b64_tr_b16 v[148:149], v6 offset:13312
    ds_read_b64_tr_b16 v[150:151], v6 offset:13440
    ds_read_b64_tr_b16 v[152:153], v6 offset:14336
    ds_read_b64_tr_b16 v[154:155], v6 offset:14464
    ds_read_b64_tr_b16 v[156:157], v6 offset:15360
    ds_read_b64_tr_b16 v[158:159], v6 offset:15488
    s_waitcnt lgkmcnt(8)
    v_mfma_f32_16x16x32_bf16 v[44:47], v[128:131], v[96:99], v[44:47]
    v_mfma_f32_16x16x32_bf16 v[48:51], v[132:135], v[100:103], v[48:51]
    v_mfma_f32_16x16x32_bf16 v[44:47], v[136:139], v[104:107], v[44:47]
    v_mfma_f32_16x16x32_bf16 v[48:51], v[140:143], v[108:111], v[48:51]
    s_waitcnt lgkmcnt(0)
    v_mfma_f32_16x16x32_bf16 v[44:47], v[144:147], v[112:115], v[44:47]
    v_mfma_f32_16x16x32_bf16 v[48:51], v[148:151], v[116:119], v[48:51]
    v_mfma_f32_16x16x32_bf16 v[44:47], v[152:155], v[120:123], v[44:47]
    v_mfma_f32_16x16x32_bf16 v[48:51], v[156:159], v[124:127], v[48:51]
    v_mov_b32 v5, 155728
    v_mov_b32 v12, 1
    ds_write_b32 v5, v12
    v_mov_b32 v5, 155716
    s_add_u32 s60, s60, 0x9e3779b9
    s_mov_b32 s21, 4194304
L_spin_3:
    ds_read_b32 v16, v5
    s_waitcnt lgkmcnt(0)
    v_readfirstlane_b32 s20, v16
    s_cmp_ge_i32 s20, 1
    s_cbranch_scc1 L_spinx_4
    s_sub_u32 s21, s21, 1
    s_cmp_lg_u32 s21, 0
    s_cbranch_scc1 L_spin_3
    s_branch L_end
L_spinx_4:
    v_add_f32 v44, v44, v48
    v_add_f32 v45, v45, v49
    v_add_f32 v46, v46, v50
    v_add_f32 v47, v47, v51
    v_cvt_pk_bf16_f32 v12, v44, v45
    v_mov_b32 v13, s60
    v_cvt_pk_bf16_f32 v14, v46, v47
    v_mov_b32 v15, s60
    s_lshl_b32 s20, s6, 6
    s_add_u32 s20, s20, 1024
    v_lshlrev_b32 v5, 4, v4
    v_cmp_eq_u32 vcc, 0, v1
    s_and_saveexec_b64 s[22:23], vcc
    buffer_store_dwordx4 v[12:15], v5, s[8:11], s20 offen sc1
    s_mov_b64 exec, -1
    s_lshl_b32 s20, s4, 11
    s_add_u32 s20, s20, 1024
    v_lshlrev_b32 v5, 4, v0
    s_mov_b64 s[72:73], -1
    s_mov_b64 s[74:75], -1
    s_mov_b32 s29, 131072
L_qpoll:
    s_mov_b64 exec, s[72:73]
    s_cbranch_execz L_sk_5
    buffer_load_dwordx4 v[16:19], v5, s[8:11], s20 offen offset:0 sc1
L_sk_5:
    s_mov_b64 exec, s[74:75]
    s_cbranch_execz L_sk_6
    buffer_load_dwordx4 v[20:23], v5, s[8:11], s20 offen offset:1024 sc1
L_sk_6:
    s_mov_b64 exec, -1
    s_mov_b64 s[26:27], 0
    s_waitcnt vmcnt(0)
    s_cmp_eq_u64 s[72:73], 0
    s_cbranch_scc1 L_sc_7
    v_cmp_ne_u32 vcc, s60, v17
    v_cmp_ne_u32 s[22:23], s60, v19
    s_or_b64 vcc, vcc, s[22:23]
    s_mov_b64 s[72:73], vcc
    s_or_b64 s[26:27], s[26:27], vcc
L_sc_7:
    s_cmp_eq_u64 s[74:75], 0
    s_cbranch_scc1 L_sc_8
    v_cmp_ne_u32 vcc, s60, v21
    v_cmp_ne_u32 s[22:23], s60, v23
    s_or_b64 vcc, vcc, s[22:23]
    s_mov_b64 s[74:75], vcc
    s_or_b64 s[26:27], s[26:27], vcc
L_sc_8:
    s_cmp_eq_u64 s[26:27], 0
    s_cbranch_scc1 L_qgot
    s_sub_u32 s29, s29, 1
    s_cmp_lg_u32 s29, 0
    s_cbranch_scc1 L_qpoll
    s_branch L_end
L_qgot:
    v_lshlrev_b32 v5, 3, v0
    v_add_u32 v5, 157184, v5
    ds_write2_b32 v5, v16, v18 offset0:0 offset1:1
    ds_write2_b32 v5, v20, v22 offset0:128 offset1:129
    v_mov_b32 v6, 155712
    v_mov_b32 v7, 1
    s_waitcnt lgkmcnt(0)
    ds_write_b32 v6, v7
    s_cmp_lt_i32 s63, 0
    s_cbranch_scc1 L_cntskip
    s_mov_b32 s16, s56
    s_and_b32 s17, s57, 0xffff
    s_mov_b32 s18, 0x100
    s_mov_b32 s19, 0x20000
    v_lshlrev_b32 v5, 5, v0
    s_mov_b32 s29, 131072
L_cntpoll:
    buffer_load_dword v6, v5, s[16:19], 0 offen sc1
    s_waitcnt vmcnt(0)
    s_nop 1
    v_add_u32_dpp v6, v6, v6 row_ror:4 row_mask:0xf bank_mask:0xf
    s_nop 1
    v_add_u32_dpp v6, v6, v6 row_ror:2 row_mask:0xf bank_mask:0xf
    s_nop 1
    v_add_u32_dpp v6, v6, v6 row_ror:1 row_mask:0xf bank_mask:0xf
    s_nop 0
    v_readlane_b32 s20, v6, 7
    s_cmp_ge_u32 s20, 256
    s_cbranch_scc1 L_cntok
    s_sleep 16
    s_sub_u32 s29, s29, 1
    s_cmp_lg_u32 s29, 0
    s_cbranch_scc1 L_cntpoll
    s_branch L_end
L_cntok:
    v_mov_b32 v6, 155720
    v_mov_b32 v7, 1
    ds_write_b32 v6, v7
L_cntskip:
    v_lshrrev_b32 v2, 1, v0
    v_and_b32 v3, 1, v0
    v_mul_u32_u24 v22, 3584, v2
    v_lshl_add_u32 v22, v3, 4, v22
    v_lshlrev_b32 v23, 4, v0
    s_lshl_b32 s20, s4, 2
    s_and_b32 s21, s5, 3
    s_add_u32 s20, s20, s21
    s_lshl_b32 s20, s20, 8
    s_add_u32 s20, s20, 20480
    v_mov_b32 v12, s20
    v_mov_b32 v2, 155648
    v_mov_b32 v13, 155732
    s_mov_b32 s30, 0
L_tkloop:
    s_lshl_b32 s31, s30, 1
    s_add_u32 s31, s31, 114
    s_mov_b32 s21, 4194304
L_spin_9:
    ds_read_b32 v3, v2
    s_waitcnt lgkmcnt(0)
    v_readfirstlane_b32 s20, v3
    s_cmp_ge_i32 s20, s31
    s_cbranch_scc1 L_spinx_10
    s_sleep 1
    s_sub_u32 s21, s21, 1
    s_cmp_lg_u32 s21, 0
    s_cbranch_scc1 L_spin_9
    s_branch L_end
L_spinx_10:
    v_mov_b32 v14, 1
    s_mov_b64 exec, 1
    buffer_atomic_add v14, v12, s[8:11], 0 offen sc0 sc1
    s_waitcnt vmcnt(0)
    s_and_b32 s31, s30, 3
    s_lshl_b32 s31, s31, 2
    s_add_u32 s31, s31, 155760
    v_mov_b32 v15, s31
    ds_write_b32 v15, v14
    s_add_u32 s30, s30, 1
    v_mov_b32 v15, s30
    s_waitcnt lgkmcnt(0)
    ds_write_b32 v13, v15
    v_readfirstlane_b32 s31, v14
    s_mov_b64 exec, -1
    s_cmp_lt_u32 s31, 32
    s_cbranch_scc1 L_tkloop
    v_mov_b32 v2, 155652
    s_mov_b32 s21, 4194304
L_nt_11:
    ds_read_b32 v3, v2
    s_waitcnt lgkmcnt(0)
    v_readfirstlane_b32 s20, v3
    s_cmp_lt_u32 s20, 0x40000000
    s_cbranch_scc1 L_ntx_12
    s_sleep 2
    s_sub_u32 s21, s21, 1
    s_cmp_lg_u32 s21, 0
    s_cbranch_scc1 L_nt_11
    s_branch L_end
L_ntx_12:
    s_cmp_eq_u32 s67, 1
    s_cbranch_scc1 L_hwo
    s_cmp_lt_i32 s63, 0
    s_cbranch_scc1 L_hexit
    s_mov_b32 s16, s48
    s_and_b32 s17, s49, 0xffff
    s_mov_b32 s18, 0x1c0000
    s_mov_b32 s19, 0x20000
    s_lshl_b32 s28, s63, 5
    s_mov_b32 m0, 114688
    s_add_u32 s30, s28, 0
    buffer_load_dwordx4 v22, s[16:19], s30 offen  lds
    s_mov_b32 m0, 115712
    s_add_u32 s30, s28, 114688
    buffer_load_dwordx4 v22, s[16:19], s30 offen  lds
    s_mov_b32 m0, 116736
    s_add_u32 s30, s28, 229376
    buffer_load_dwordx4 v22, s[16:19], s30 offen  lds
    s_mov_b32 m0, 117760
    s_add_u32 s30, s28, 344064
    buffer_load_dwordx4 v22, s[16:19], s30 offen  lds
    s_mov_b32 m0, 118784
    s_add_u32 s30, s28, 458752
    buffer_load_dwordx4 v22, s[16:19], s30 offen  lds
    s_mov_b32 m0, 119808
    s_add_u32 s30, s28, 573440
    buffer_load_dwordx4 v22, s[16:19], s30 offen  lds
    s_mov_b32 m0, 120832
    s_add_u32 s30, s28, 688128
    buffer_load_dwordx4 v22, s[16:19], s30 offen  lds
    s_mov_b32 m0, 121856
    s_add_u32 s30, s28, 802816
    buffer_load_dwordx4 v22, s[16:19], s30 offen  lds
    s_mov_b32 m0, 122880
    s_add_u32 s30, s28, 917504
    buffer_load_dwordx4 v22, s[16:19], s30 offen  lds
    s_mov_b32 m0, 123904
    s_add_u32 s30, s28, 1032192
    buffer_load_dwordx4 v22, s[16:19], s30 offen  lds
    s_mov_b32 m0, 124928
    s_add_u32 s30, s28, 1146880
    buffer_load_dwordx4 v22, s[16:19], s30 offen  lds
    s_mov_b32 m0, 125952
    s_add_u32 s30, s28, 1261568
    buffer_load_dwordx4 v22, s[16:19], s30 offen  lds
    s_mov_b32 m0, 126976
    s_add_u32 s30, s28, 1376256
    buffer_load_dwordx4 v22, s[16:19], s30 offen  lds
    s_mov_b32 m0, 128000
    s_add_u32 s30, s28, 1490944
    buffer_load_dwordx4 v22, s[16:19], s30 offen  lds
    s_mov_b32 m0, 129024
    s_add_u32 s30, s28, 1605632
    buffer_load_dwordx4 v22, s[16:19], s30 offen  lds
    s_mov_b32 m0, 130048
    s_add_u32 s30, s28, 1720320
    buffer_load_dwordx4 v22, s[16:19], s30 offen  lds
    v_mov_b32 v2, 155752
    s_mov_b32 s21, 4194304
L_spin_13:
    ds_read_b32 v3, v2
    s_waitcnt lgkmcnt(0)
    v_readfirstlane_b32 s20, v3
    s_cmp_ge_i32 s20, 4
    s_cbranch_scc1 L_spinx_14
    s_sub_u32 s21, s21, 1
    s_cmp_lg_u32 s21, 0
    s_cbranch_scc1 L_spin_13
    s_branch L_end
L_spinx_14:
    s_mov_b32 s16, s50
    s_and_b32 s17, s51, 0xffff
    s_mov_b32 s18, 0x1c0000
    s_mov_b32 s19, 0x20000
    s_lshl_b32 s28, s63, 5
    s_mov_b32 m0, 131072
    s_add_u32 s30, s28, 0
    buffer_load_dwordx4 v22, s[16:19], s30 offen  lds
    s_mov_b32 m0, 132096
    s_add_u32 s30, s28, 114688
    buffer_load_dwordx4 v22, s[16:19], s30 offen  lds
    s_mov_b32 m0, 133120
    s_add_u32 s30, s28, 229376
    buffer_load_dwordx4 v22, s[16:19], s30 offen  lds
    s_mov_b32 m0, 134144
    s_add_u32 s30, s28, 344064
    buffer_load_dwordx4 v22, s[16:19], s30 offen  lds
    s_mov_b32 m0, 135168
    s_add_u32 s30, s28, 458752
    buffer_load_dwordx4 v22, s[16:19], s30 offen  lds
    s_mov_b32 m0, 136192
    s_add_u32 s30, s28, 573440
    buffer_load_dwordx4 v22, s[16:19], s30 offen  lds
    s_mov_b32 m0, 137216
    s_add_u32 s30, s28, 688128
    buffer_load_dwordx4 v22, s[16:19], s30 offen  lds
    s_mov_b32 m0, 138240
    s_add_u32 s30, s28, 802816
    buffer_load_dwordx4 v22, s[16:19], s30 offen  lds
    s_mov_b32 m0, 139264
    s_add_u32 s30, s28, 917504
    buffer_load_dwordx4 v22, s[16:19], s30 offen  lds
    s_mov_b32 m0, 140288
    s_add_u32 s30, s28, 1032192
    buffer_load_dwordx4 v22, s[16:19], s30 offen  lds
    s_mov_b32 m0, 141312
    s_add_u32 s30, s28, 1146880
    buffer_load_dwordx4 v22, s[16:19], s30 offen  lds
    s_mov_b32 m0, 142336
    s_add_u32 s30, s28, 1261568
    buffer_load_dwordx4 v22, s[16:19], s30 offen  lds
    s_mov_b32 m0, 143360
    s_add_u32 s30, s28, 1376256
    buffer_load_dwordx4 v22, s[16:19], s30 offen  lds
    s_mov_b32 m0, 144384
    s_add_u32 s30, s28, 1490944
    buffer_load_dwordx4 v22, s[16:19], s30 offen  lds
    s_mov_b32 m0, 145408
    s_add_u32 s30, s28, 1605632
    buffer_load_dwordx4 v22, s[16:19], s30 offen  lds
    s_mov_b32 m0, 146432
    s_add_u32 s30, s28, 1720320
    buffer_load_dwordx4 v22, s[16:19], s30 offen  lds
    s_mov_b32 s16, s52
    s_and_b32 s17, s53, 0xffff
    s_mov_b32 s18, 0x1c0000
    s_mov_b32 s19, 0x20000
    s_lshl_b32 s28, s63, 14
    s_mov_b32 m0, 0
    s_add_u32 s30, s28, 0
    buffer_load_dwordx4 v23, s[16:19], s30 offen  lds
    s_mov_b32 m0, 1024
    s_add_u32 s30, s28, 1024
    buffer_load_dwordx4 v23, s[16:19], s30 offen  lds
    s_mov_b32 m0, 2048
    s_add_u32 s30, s28, 2048
    buffer_load_dwordx4 v23, s[16:19], s30 offen  lds
    s_mov_b32 m0, 3072
    s_add_u32 s30, s28, 3072
    buffer_load_dwordx4 v23, s[16:19], s30 offen  lds
    s_mov_b32 m0, 4096
    s_add_u32 s30, s28, 4096
    buffer_load_dwordx4 v23, s[16:19], s30 offen  lds
    s_mov_b32 m0, 5120
    s_add_u32 s30, s28, 5120
    buffer_load_dwordx4 v23, s[16:19], s30 offen  lds
    s_mov_b32 m0, 6144
    s_add_u32 s30, s28, 6144
    buffer_load_dwordx4 v23, s[16:19], s30 offen  lds
    s_mov_b32 m0, 7168
    s_add_u32 s30, s28, 7168
    buffer_load_dwordx4 v23, s[16:19], s30 offen  lds
    s_mov_b32 m0, 8192
    s_add_u32 s30, s28, 8192
    buffer_load_dwordx4 v23, s[16:19], s30 offen  lds
    s_mov_b32 m0, 9216
    s_add_u32 s30, s28, 9216
    buffer_load_dwordx4 v23, s[16:19], s30 offen  lds
    s_mov_b32 m0, 10240
    s_add_u32 s30, s28, 10240
    buffer_load_dwordx4 v23, s[16:19], s30 offen  lds
    s_mov_b32 m0, 11264
    s_add_u32 s30, s28, 11264
    buffer_load_dwordx4 v23, s[16:19], s30 offen  lds
    s_mov_b32 m0, 12288
    s_add_u32 s30, s28, 12288
    buffer_load_dwordx4 v23, s[16:19], s30 offen  lds
    s_mov_b32 m0, 13312
    s_add_u32 s30, s28, 13312
    buffer_load_dwordx4 v23, s[16:19], s30 offen  lds
    s_mov_b32 m0, 14336
    s_add_u32 s30, s28, 14336
    buffer_load_dwordx4 v23, s[16:19], s30 offen  lds
    s_mov_b32 m0, 15360
    s_add_u32 s30, s28, 15360
    buffer_load_dwordx4 v23, s[16:19], s30 offen  lds
    v_mov_b32 v2, 155724
    v_mov_b32 v3, 3
    s_waitcnt vmcnt(0)
    ds_write_b32 v2, v3
    s_waitcnt lgkmcnt(0)
L_hexit:
    s_endpgm
L_hwo:
    v_lshrrev_b32 v2, 3, v0
    v_and_b32 v3, 7, v0
    v_lshlrev_b32 v21, 10, v2
    v_lshl_add_u32 v21, v3, 4, v21
    s_mov_b32 s16, s44
    s_and_b32 s17, s45, 0xffff
    s_mov_b32 s18, 0x400000
    s_mov_b32 s19, 0x20000
    s_lshl_b32 s28, s4, 19
    s_lshl_b32 s30, s61, 18
    s_add_u32 s28, s28, s30
    s_lshl_b32 s30, s62, 7
    s_add_u32 s28, s28, s30
    s_mov_b32 m0, 114688
    s_add_u32 s30, s28, 0
    buffer_load_dwordx4 v21, s[16:19], s30 offen  lds
    s_mov_b32 m0, 115712
    s_add_u32 s30, s28, 8192
    buffer_load_dwordx4 v21, s[16:19], s30 offen  lds
    s_mov_b32 m0, 116736
    s_add_u32 s30, s28, 16384
    buffer_load_dwordx4 v21, s[16:19], s30 offen  lds
    s_mov_b32 m0, 117760
    s_add_u32 s30, s28, 24576
    buffer_load_dwordx4 v21, s[16:19], s30 offen  lds
    s_mov_b32 m0, 118784
    s_add_u32 s30, s28, 32768
    buffer_load_dwordx4 v21, s[16:19], s30 offen  lds
    s_mov_b32 m0, 119808
    s_add_u32 s30, s28, 40960
    buffer_load_dwordx4 v21, s[16:19], s30 offen  lds
    s_mov_b32 m0, 120832
    s_add_u32 s30, s28, 49152
    buffer_load_dwordx4 v21, s[16:19], s30 offen  lds
    s_mov_b32 m0, 121856
    s_add_u32 s30, s28, 57344
    buffer_load_dwordx4 v21, s[16:19], s30 offen  lds
    s_mov_b32 m0, 122880
    s_add_u32 s30, s28, 65536
    buffer_load_dwordx4 v21, s[16:19], s30 offen  lds
    s_mov_b32 m0, 123904
    s_add_u32 s30, s28, 73728
    buffer_load_dwordx4 v21, s[16:19], s30 offen  lds
    s_mov_b32 m0, 124928
    s_add_u32 s30, s28, 81920
    buffer_load_dwordx4 v21, s[16:19], s30 offen  lds
    s_mov_b32 m0, 125952
    s_add_u32 s30, s28, 90112
    buffer_load_dwordx4 v21, s[16:19], s30 offen  lds
    s_mov_b32 m0, 126976
    s_add_u32 s30, s28, 98304
    buffer_load_dwordx4 v21, s[16:19], s30 offen  lds
    s_mov_b32 m0, 128000
    s_add_u32 s30, s28, 106496
    buffer_load_dwordx4 v21, s[16:19], s30 offen  lds
    s_mov_b32 m0, 129024
    s_add_u32 s30, s28, 114688
    buffer_load_dwordx4 v21, s[16:19], s30 offen  lds
    s_mov_b32 m0, 130048
    s_add_u32 s30, s28, 122880
    buffer_load_dwordx4 v21, s[16:19], s30 offen  lds
    s_mov_b32 m0, 131072
    s_add_u32 s30, s28, 131072
    buffer_load_dwordx4 v21, s[16:19], s30 offen  lds
    s_mov_b32 m0, 132096
    s_add_u32 s30, s28, 139264
    buffer_load_dwordx4 v21, s[16:19], s30 offen  lds
    s_mov_b32 m0, 133120
    s_add_u32 s30, s28, 147456
    buffer_load_dwordx4 v21, s[16:19], s30 offen  lds
    s_mov_b32 m0, 134144
    s_add_u32 s30, s28, 155648
    buffer_load_dwordx4 v21, s[16:19], s30 offen  lds
    s_mov_b32 m0, 135168
    s_add_u32 s30, s28, 163840
    buffer_load_dwordx4 v21, s[16:19], s30 offen  lds
    s_mov_b32 m0, 136192
    s_add_u32 s30, s28, 172032
    buffer_load_dwordx4 v21, s[16:19], s30 offen  lds
    s_mov_b32 m0, 137216
    s_add_u32 s30, s28, 180224
    buffer_load_dwordx4 v21, s[16:19], s30 offen  lds
    s_mov_b32 m0, 138240
    s_add_u32 s30, s28, 188416
    buffer_load_dwordx4 v21, s[16:19], s30 offen  lds
    s_mov_b32 m0, 139264
    s_add_u32 s30, s28, 196608
    buffer_load_dwordx4 v21, s[16:19], s30 offen  lds
    s_mov_b32 m0, 140288
    s_add_u32 s30, s28, 204800
    buffer_load_dwordx4 v21, s[16:19], s30 offen  lds
    s_mov_b32 m0, 141312
    s_add_u32 s30, s28, 212992
    buffer_load_dwordx4 v21, s[16:19], s30 offen  lds
    s_mov_b32 m0, 142336
    s_add_u32 s30, s28, 221184
    buffer_load_dwordx4 v21, s[16:19], s30 offen  lds
    s_mov_b32 m0, 143360
    s_add_u32 s30, s28, 229376
    buffer_load_dwordx4 v21, s[16:19], s30 offen  lds
    s_mov_b32 m0, 144384
    s_add_u32 s30, s28, 237568
    buffer_load_dwordx4 v21, s[16:19], s30 offen  lds
    s_mov_b32 m0, 145408
    s_add_u32 s30, s28, 245760
    buffer_load_dwordx4 v21, s[16:19], s30 offen  lds
    s_mov_b32 m0, 146432
    s_add_u32 s30, s28, 253952
    buffer_load_dwordx4 v21, s[16:19], s30 offen  lds
    v_mov_b32 v2, 155724
    v_mov_b32 v3, 1
    s_waitcnt vmcnt(0)
    ds_write_b32 v2, v3
    s_waitcnt lgkmcnt(0)
    s_endpgm
L_consumer:
    s_sub_u32 s3, s3, 2
    v_and_b32 v6, 31, v0
    v_lshlrev_b32 v5, 3, v6
    s_lshl_b32 s20, s3, 8
    v_add_u32 v5, s20, v5
    s_waitcnt lgkmcnt(0)
    s_mov_b32 s8, s58
    s_and_b32 s9, s59, 0xffff
    s_mov_b32 s10, 0x200000
    s_mov_b32 s11, 0x20000
    s_mov_b32 s12, s36
    s_and_b32 s13, s37, 0xffff
    s_mov_b32 s14, 0x400
    s_mov_b32 s15, 0x20000
    buffer_load_dwordx2 v[8:9], v5, s[12:15], 0 offen
    s_load_dword s60, s[58:59], 0
    v_lshlrev_b32 v5, 4, v0
    s_cmp_eq_u32 s3, 0
    s_cbranch_scc0 L_noinit
    v_subrev_u32 v6, 4, v0
    v_mov_b32 v7, 0
    v_cmp_gt_u32 vcc, 6, v6
    s_nop 1
    v_cndmask_b32 v7, v7, v6, vcc
    v_cmp_eq_u32 vcc, 1, v0
    v_mov_b32 v6, 0x40000000
    s_nop 0
    v_cndmask_b32 v7, v7, v6, vcc
    v_lshlrev_b32 v6, 2, v0
    v_add_u32 v6, 155648, v6
    ds_write_b32 v6, v7
    s_waitcnt lgkmcnt(0)
L_noinit:
    s_cmp_eq_u32 s3, 1
    s_cbranch_scc0 L_norst
    v_mov_b32 v12, -1
    v_mov_b32 v13, -1
    v_mov_b32 v14, -1
    v_mov_b32 v15, -1
    s_lshl_b32 s20, s6, 11
    s_add_u32 s20, s20, 1572864
    buffer_store_dwordx4 v[12:15], v5, s[8:11], s20 offen sc1
    buffer_store_dwordx4 v[12:15], v5, s[8:11], s20 offen offset:1024 sc1
    s_cmp_eq_u32 s67, 1
    s_cbranch_scc0 L_nop2
    v_lshlrev_b32 v6, 15, v4
    v_lshl_add_u32 v6, v1, 4, v6
    s_add_u32 s22, s64, 393216
    s_add_u32 s23, s22, 131072
    buffer_store_dwordx4 v[12:15], v6, s[8:11], s22 offen sc1
    buffer_store_dwordx4 v[12:15], v6, s[8:11], s23 offen sc1
L_nop2:
    s_and_b32 s20, s2, 7
    s_cmp_eq_u32 s20, 0
    s_cbranch_scc0 L_notk
    s_lshl_b32 s20, s4, 2
    s_and_b32 s21, s5, 3
    s_add_u32 s20, s20, s21
    s_lshl_b32 s20, s20, 8
    s_add_u32 s20, s20, 20480
    v_mov_b32 v6, 0
    v_mov_b32 v7, 0
    s_mov_b64 exec, 1
    buffer_store_dword v6, v7, s[8:11], s20 offen sc1
    s_mov_b64 exec, -1
L_notk:
    s_cmp_lt_i32 s63, 0
    s_cbranch_scc1 L_norst
    s_lshl_b32 s20, s63, 11
    s_add_u32 s20, s20, 655360
    buffer_store_dwordx4 v[12:15], v5, s[8:11], s20 offen sc1
    buffer_store_dwordx4 v[12:15], v5, s[8:11], s20 offen offset:1024 sc1
L_norst:
    s_barrier
    s_cmp_eq_u32 s3, 1
    s_cbranch_scc0 L_norst2
    s_waitcnt vmcnt(0)
    s_mov_b32 s16, s56
    s_and_b32 s17, s57, 0xffff
    s_mov_b32 s18, 0x100
    s_mov_b32 s19, 0x20000
    v_mov_b32 v5, 155716
    v_mov_b32 v6, 1
    s_and_b32 s20, s2, 7
    s_lshl_b32 s20, s20, 5
    v_mov_b32 v7, s20
    s_mov_b64 exec, 1
    ds_write_b32 v5, v6
    buffer_atomic_add v6, v7, s[16:19], 0 offen sc1
    s_mov_b64 exec, -1
L_norst2:
    v_xor_b32 v5, v1, v4
    v_lshlrev_b32 v5, 4, v5
    v_lshl_add_u32 v5, v1, 8, v5
    v_xor_b32 v140, 0, v5
    v_xor_b32 v141, 64, v5
    v_xor_b32 v142, 128, v5
    v_xor_b32 v143, 192, v5
    v_lshrrev_b32 v5, 2, v0
    v_and_b32 v6, 7, v5
    v_lshlrev_b32 v5, 8, v5
    v_lshl_add_u32 v5, v6, 5, v5
    v_and_b32 v6, 3, v0
    v_lshl_add_u32 v5, v6, 3, v5
    v_xor_b32 v144, 0, v5
    v_add_u32 v144, 8192, v144
    v_xor_b32 v145, 32, v5
    v_add_u32 v145, 8192, v145
    v_xor_b32 v146, 64, v5
    v_add_u32 v146, 8192, v146
    v_xor_b32 v147, 96, v5
    v_add_u32 v147, 8192, v147
    v_xor_b32 v148, 128, v5
    v_add_u32 v148, 8192, v148
    v_xor_b32 v149, 160, v5
    v_add_u32 v149, 8192, v149
    v_xor_b32 v150, 192, v5
    v_add_u32 v150, 8192, v150
    v_xor_b32 v151, 224, v5
    v_add_u32 v151, 8192, v151
    v_mov_b32 v96, 0
    v_mov_b32 v97, 0
    v_mov_b32 v98, 0
    v_mov_b32 v99, 0
    v_mov_b32 v100, 0
    v_mov_b32 v101, 0
    v_mov_b32 v102, 0
    v_mov_b32 v103, 0
    v_mov_b32 v104, 0
    v_mov_b32 v105, 0
    v_mov_b32 v106, 0
    v_mov_b32 v107, 0
    v_mov_b32 v108, 0
    v_mov_b32 v109, 0
    v_mov_b32 v110, 0
    v_mov_b32 v111, 0
    v_mov_b32 v112, 0
    v_mov_b32 v113, 0
    v_mov_b32 v114, 0
    v_mov_b32 v115, 0
    v_mov_b32 v116, 0
    v_mov_b32 v117, 0
    v_mov_b32 v118, 0
    v_mov_b32 v119, 0
    v_mov_b32 v120, 0
    v_mov_b32 v121, 0
    v_mov_b32 v122, 0
    v_mov_b32 v123, 0
    v_mov_b32 v124, 0
    v_mov_b32 v125, 0
    v_mov_b32 v126, 0
    v_mov_b32 v127, 0
    v_mov_b32 v164, 0xff7fffff
    v_mov_b32 v172, 0
    v_mov_b32 v176, 0x3f803f80
    v_mov_b32 v173, 0
    v_mov_b32 v177, 0x3f803f80
    v_mov_b32 v174, 0
    v_mov_b32 v178, 0x3f803f80
    v_mov_b32 v175, 0
    v_mov_b32 v179, 0x3f803f80
    s_lshl_b32 s26, s3, 5
    s_add_u32 s26, s26, 158208
    v_lshlrev_b32 v5, 3, v0
    v_add_u32 v180, s26, v5
    s_lshl_b32 s26, s3, 11
    s_add_u32 s26, s26, 98304
    v_lshlrev_b32 v5, 9, v1
    v_lshl_add_u32 v5, v4, 4, v5
    v_add_u32 v181, s26, v5
    s_lshl_b32 s26, s3, 3
    s_add_u32 s26, s26, 158208
    v_mov_b32 v182, s26
    v_and_b32 v6, 31, v0
    s_lshl_b32 s26, s3, 9
    v_lshl_add_u32 v5, v6, 4, s26
    v_add_u32 v183, 98304, v5
    v_add_u32 v184, 100352, v5
    v_add_u32 v185, 102400, v5
    v_add_u32 v186, 104448, v5
    v_lshlrev_b32 v187, 4, v6
    s_lshl_b32 s65, s6, 11
    s_lshl_b32 s26, s3, 9
    s_add_u32 s65, s65, s26
    s_add_u32 s65, s65, 1572864
    s_lshr_b32 s26, s3, 1
    s_and_b32 s27, s3, 1
    s_lshl_b32 s28, s61, 1
    s_add_u32 s28, s28, s26
    v_lshlrev_b32 v5, 14, v4
    v_lshl_add_u32 v5, v1, 4, v5
    s_lshl_b32 s22, s27, 8
    v_add_u32 v188, s22, v5
    v_add_u32 v189, 4096, v188
    v_add_u32 v190, 8192, v188
    v_add_u32 v191, 12288, v188
    s_lshl_b32 s66, s4, 16
    s_lshl_b32 s21, s28, 9
    s_add_u32 s66, s66, s21
    s_add_u32 s66, s66, 1572864
    s_lshl_b32 s22, s26, 8
    s_lshl_b32 s21, s27, 7
    s_add_u32 s22, s22, s21
    s_add_u32 s22, s22, 158720
    v_lshl_add_u32 v192, v1, 3, s22
    v_lshlrev_b32 v195, 4, v4
    v_add_u32 v195, 158720, v195
    v_bfe_u32 v5, v0, 2, 2
    v_lshl_add_u32 v5, v4, 3, v5
    v_lshlrev_b32 v5, 7, v5
    v_and_b32 v7, 3, v0
    v_lshl_add_u32 v5, v7, 3, v5
    s_lshl_b32 s22, s3, 5
    s_add_u32 s22, s22, 114688
    v_add_u32 v193, s22, v5
    v_lshlrev_b32 v198, 6, v7
    v_lshrrev_b32 v5, 2, v0
    v_lshlrev_b32 v5, 15, v5
    v_lshl_add_u32 v199, v7, 4, v5
    s_lshl_b32 s35, s3, 6
    s_add_u32 s35, s35, s64
    s_add_u32 s35, s35, 393216
    v_mov_b32 v194, 155744
    v_mov_b32 v196, 1
    v_mov_b32 v197, 155652
    v_mov_b32 v2, 155648
    s_mov_b32 s24, s3
    s_lshl_b32 s25, s3, 14
    v_add_u32 v152, s25, v140
    v_add_u32 v153, s25, v141
    v_add_u32 v154, s25, v142
    v_add_u32 v155, s25, v143
    v_add_u32 v156, s25, v144
    v_add_u32 v157, s25, v145
    v_add_u32 v158, s25, v146
    v_add_u32 v159, s25, v147
    v_add_u32 v160, s25, v148
    v_add_u32 v161, s25, v149
    v_add_u32 v162, s25, v150
    v_add_u32 v163, s25, v151
    s_lshl_b32 s26, s24, 1
    s_add_u32 s26, s26, 1
    s_mov_b32 s21, 4194304
L_spin_15:
    ds_read_b32 v3, v2
    s_waitcnt lgkmcnt(0)
    v_readfirstlane_b32 s20, v3
    s_cmp_ge_i32 s20, s26
    s_cbranch_scc1 L_spinx_16
    s_sleep 1
    s_sub_u32 s21, s21, 1
    s_cmp_lg_u32 s21, 0
    s_cbranch_scc1 L_spin_15
    s_branch L_end
L_spinx_16:
    ds_read_b128 v[32:35], v152 offset:0
    ds_read_b128 v[36:39], v153 offset:0
    ds_read_b128 v[40:43], v154 offset:0
    ds_read_b128 v[44:47], v155 offset:0
    ds_read_b128 v[48:51], v152 offset:4096
    ds_read_b128 v[52:55], v153 offset:4096
    ds_read_b128 v[56:59], v154 offset:4096
    ds_read_b128 v[60:63], v155 offset:4096
    s_add_u32 s26, s26, 1
    s_mov_b32 s21, 4194304
L_spin_17:
    ds_read_b32 v3, v2
    s_waitcnt lgkmcnt(0)
    v_readfirstlane_b32 s20, v3
    s_cmp_ge_i32 s20, s26
    s_cbranch_scc1 L_spinx_18
    s_sleep 1
    s_sub_u32 s21, s21, 1
    s_cmp_lg_u32 s21, 0
    s_cbranch_scc1 L_spin_17
    s_branch L_end
L_spinx_18:
    ds_read_b64_tr_b16 v[64:65], v156
    ds_read_b64_tr_b16 v[66:67], v156 offset:4096
    ds_read_b64_tr_b16 v[68:69], v157
    ds_read_b64_tr_b16 v[70:71], v157 offset:4096
    ds_read_b64_tr_b16 v[72:73], v158
    ds_read_b64_tr_b16 v[74:75], v158 offset:4096
    ds_read_b64_tr_b16 v[76:77], v159
    ds_read_b64_tr_b16 v[78:79], v159 offset:4096
    s_waitcnt lgkmcnt(4)
    ds_read_b64_tr_b16 v[80:81], v160
    ds_read_b64_tr_b16 v[82:83], v160 offset:4096
    ds_read_b64_tr_b16 v[84:85], v161
    ds_read_b64_tr_b16 v[86:87], v161 offset:4096
    ds_read_b64_tr_b16 v[88:89], v162
    ds_read_b64_tr_b16 v[90:91], v162 offset:4096
    ds_read_b64_tr_b16 v[92:93], v163
    ds_read_b64_tr_b16 v[94:95], v163 offset:4096
    s_waitcnt lgkmcnt(0)
    s_lshr_b32 s26, s25, 12
    s_add_u32 s26, s26, 155664
    v_mov_b32 v166, s26
    s_add_u32 s26, s24, 6
    v_mov_b32 v167, s26
    ds_write_b32 v166, v167
    v_mov_b32 v5, 155712
    s_mov_b32 s21, 4194304
L_spin_19:
    ds_read_b32 v6, v5
    s_waitcnt lgkmcnt(0)
    v_readfirstlane_b32 s20, v6
    s_cmp_ge_i32 s20, 1
    s_cbranch_scc1 L_spinx_20
    s_sleep 1
    s_sub_u32 s21, s21, 1
    s_cmp_lg_u32 s21, 0
    s_cbranch_scc1 L_spin_19
    s_branch L_end
L_spinx_20:
    v_and_b32 v5, 3, v1
    v_lshlrev_b32 v5, 8, v5
    v_lshl_add_u32 v5, v4, 4, v5
    v_add_u32 v5, 157184, v5
    ds_read_b128 v[16:19], v5 offset:0
    ds_read_b128 v[20:23], v5 offset:64
    ds_read_b128 v[24:27], v5 offset:128
    ds_read_b128 v[28:31], v5 offset:192
    s_waitcnt lgkmcnt(0)
    v_mfma_f32_16x16x32_bf16 v[128:131], v[32:35], v[16:19], 0
    v_mfma_f32_16x16x32_bf16 v[128:131], v[36:39], v[20:23], v[128:131]
    v_mfma_f32_16x16x32_bf16 v[128:131], v[40:43], v[24:27], v[128:131]
    v_mfma_f32_16x16x32_bf16 v[128:131], v[44:47], v[28:31], v[128:131]
    v_mfma_f32_16x16x32_bf16 v[132:135], v[48:51], v[16:19], 0
    v_mfma_f32_16x16x32_bf16 v[132:135], v[52:55], v[20:23], v[132:135]
    v_mfma_f32_16x16x32_bf16 v[132:135], v[56:59], v[24:27], v[132:135]
    v_mfma_f32_16x16x32_bf16 v[132:135], v[60:63], v[28:31], v[132:135]
    s_nop 7
    v_cvt_pk_bf16_f32 v166, v128, v129
    v_cvt_pk_bf16_f32 v167, v130, v131
    v_cvt_pk_bf16_f32 v168, v132, v133
    v_cvt_pk_bf16_f32 v169, v134, v135
    v_lshlrev_b32 v128, 16, v166
    v_and_b32 v129, 0xffff0000, v166
    v_lshlrev_b32 v130, 16, v167
    v_and_b32 v131, 0xffff0000, v167
    v_lshlrev_b32 v132, 16, v168
    v_and_b32 v133, 0xffff0000, v168
    v_lshlrev_b32 v134, 16, v169
    v_and_b32 v135, 0xffff0000, v169
    v_mul_f32 v128, 0x3db504f3, v128
    v_mul_f32 v129, 0x3db504f3, v129
    v_mul_f32 v130, 0x3db504f3, v130
    v_mul_f32 v131, 0x3db504f3, v131
    v_mul_f32 v132, 0x3db504f3, v132
    v_mul_f32 v133, 0x3db504f3, v133
    v_mul_f32 v134, 0x3db504f3, v134
    v_mul_f32 v135, 0x3db504f3, v135
    v_cvt_pk_bf16_f32 v166, v128, v129
    v_cvt_pk_bf16_f32 v167, v130, v131
    v_cvt_pk_bf16_f32 v168, v132, v133
    v_cvt_pk_bf16_f32 v169, v134, v135
    v_lshlrev_b32 v128, 16, v166
    v_and_b32 v129, 0xffff0000, v166
    v_lshlrev_b32 v130, 16, v167
    v_and_b32 v131, 0xffff0000, v167
    v_lshlrev_b32 v132, 16, v168
    v_and_b32 v133, 0xffff0000, v168
    v_lshlrev_b32 v134, 16, v169
    v_and_b32 v135, 0xffff0000, v169
    v_mul_f32 v128, 0x3fb8aa3b, v128
    v_mul_f32 v129, 0x3fb8aa3b, v129
    v_mul_f32 v130, 0x3fb8aa3b, v130
    v_mul_f32 v131, 0x3fb8aa3b, v131
    v_mul_f32 v132, 0x3fb8aa3b, v132
    v_mul_f32 v133, 0x3fb8aa3b, v133
    v_mul_f32 v134, 0x3fb8aa3b, v134
    v_mul_f32 v135, 0x3fb8aa3b, v135
    v_max3_f32 v166, v128, v129, v130
    v_max3_f32 v167, v131, v132, v133
    v_max3_f32 v166, v166, v134, v135
    v_max_f32 v166, v166, v167
    v_cmp_gt_f32 vcc, v166, v164
    s_cbranch_vccz L_nomax_first
    v_mov_b32 v167, v166
    s_nop 1
    v_permlane16_swap_b32 v167, v166
    s_nop 0
    v_max_f32 v166, v167, v166
    v_mov_b32 v167, v166
    s_nop 1
    v_permlane32_swap_b32 v167, v166
    s_nop 0
    v_max_f32 v166, v167, v166
    v_max_f32 v166, v166, v164
    v_sub_f32 v167, v164, v166
    v_exp_f32 v167, v167
    v_mov_b32 v164, v166
    v_mul_f32 v172, v172, v167
    v_pk_mul_f32 v[96:97], v[96:97], v[166:167] op_sel:[0,1] op_sel_hi:[1,1]
    v_pk_mul_f32 v[98:99], v[98:99], v[166:167] op_sel:[0,1] op_sel_hi:[1,1]
    v_pk_mul_f32 v[100:101], v[100:101], v[166:167] op_sel:[0,1] op_sel_hi:[1,1]
    v_pk_mul_f32 v[102:103], v[102:103], v[166:167] op_sel:[0,1] op_sel_hi:[1,1]
    v_pk_mul_f32 v[104:105], v[104:105], v[166:167] op_sel:[0,1] op_sel_hi:[1,1]
    v_pk_mul_f32 v[106:107], v[106:107], v[166:167] op_sel:[0,1] op_sel_hi:[1,1]
    v_pk_mul_f32 v[108:109], v[108:109], v[166:167] op_sel:[0,1] op_sel_hi:[1,1]
    v_pk_mul_f32 v[110:111], v[110:111], v[166:167] op_sel:[0,1] op_sel_hi:[1,1]
    v_pk_mul_f32 v[112:113], v[112:113], v[166:167] op_sel:[0,1] op_sel_hi:[1,1]
    v_pk_mul_f32 v[114:115], v[114:115], v[166:167] op_sel:[0,1] op_sel_hi:[1,1]
    v_pk_mul_f32 v[116:117], v[116:117], v[166:167] op_sel:[0,1] op_sel_hi:[1,1]
    v_pk_mul_f32 v[118:119], v[118:119], v[166:167] op_sel:[0,1] op_sel_hi:[1,1]
    v_pk_mul_f32 v[120:121], v[120:121], v[166:167] op_sel:[0,1] op_sel_hi:[1,1]
    v_pk_mul_f32 v[122:123], v[122:123], v[166:167] op_sel:[0,1] op_sel_hi:[1,1]
    v_pk_mul_f32 v[124:125], v[124:125], v[166:167] op_sel:[0,1] op_sel_hi:[1,1]
    v_pk_mul_f32 v[126:127], v[126:127], v[166:167] op_sel:[0,1] op_sel_hi:[1,1]
L_nomax_first:
    v_sub_f32 v128, v128, v164
    v_sub_f32 v129, v129, v164
    v_sub_f32 v130, v130, v164
    v_sub_f32 v131, v131, v164
    v_sub_f32 v132, v132, v164
    v_sub_f32 v133, v133, v164
    v_sub_f32 v134, v134, v164
    v_sub_f32 v135, v135, v164
    v_exp_f32 v128, v128
    v_exp_f32 v129, v129
    v_exp_f32 v130, v130
    v_exp_f32 v131, v131
    v_exp_f32 v132, v132
    v_exp_f32 v133, v133
    v_exp_f32 v134, v134
    v_exp_f32 v135, v135
    s_nop 0
    v_cvt_pk_bf16_f32 v136, v128, v129
    v_cvt_pk_bf16_f32 v137, v130, v131
    v_cvt_pk_bf16_f32 v138, v132, v133
    v_cvt_pk_bf16_f32 v139, v134, v135
    s_nop 1
    v_mfma_f32_16x16x32_bf16 v[172:175], v[176:179], v[136:139], v[172:175]
    v_mfma_f32_16x16x32_bf16 v[96:99], v[64:67], v[136:139], v[96:99]
    v_mfma_f32_16x16x32_bf16 v[100:103], v[68:71], v[136:139], v[100:103]
    v_mfma_f32_16x16x32_bf16 v[104:107], v[72:75], v[136:139], v[104:107]
    v_mfma_f32_16x16x32_bf16 v[108:111], v[76:79], v[136:139], v[108:111]
    v_mfma_f32_16x16x32_bf16 v[112:115], v[80:83], v[136:139], v[112:115]
    v_mfma_f32_16x16x32_bf16 v[116:119], v[84:87], v[136:139], v[116:119]
    v_mfma_f32_16x16x32_bf16 v[120:123], v[88:91], v[136:139], v[120:123]
    v_mfma_f32_16x16x32_bf16 v[124:127], v[92:95], v[136:139], v[124:127]
    s_add_u32 s24, s24, 4
    s_add_u32 s25, s25, 65536
    s_cmp_ge_u32 s25, 98304
    s_cselect_b32 s26, 98304, 0
    s_sub_u32 s25, s25, s26
L_chunk:
    v_add_u32 v152, s25, v140
    v_add_u32 v153, s25, v141
    v_add_u32 v154, s25, v142
    v_add_u32 v155, s25, v143
    v_add_u32 v156, s25, v144
    v_add_u32 v157, s25, v145
    v_add_u32 v158, s25, v146
    v_add_u32 v159, s25, v147
    v_add_u32 v160, s25, v148
    v_add_u32 v161, s25, v149
    v_add_u32 v162, s25, v150
    v_add_u32 v163, s25, v151
    s_lshl_b32 s26, s24, 1
    s_add_u32 s26, s26, 1
    s_mov_b32 s21, 4194304
L_kspin:
    ds_read_b64 v[6:7], v2
    s_waitcnt lgkmcnt(0)
    v_readfirstlane_b32 s20, v6
    v_readfirstlane_b32 s22, v7
    s_cmp_ge_i32 s24, s22
    s_cbranch_scc1 L_attn_done
    s_cmp_ge_i32 s20, s26
    s_cbranch_scc1 L_kgot
    s_sub_u32 s21, s21, 1
    s_cmp_lg_u32 s21, 0
    s_cbranch_scc1 L_kspin
    s_branch L_end
L_kgot:
    ds_read_b128 v[32:35], v152 offset:0
    ds_read_b128 v[36:39], v153 offset:0
    ds_read_b128 v[40:43], v154 offset:0
    ds_read_b128 v[44:47], v155 offset:0
    ds_read_b128 v[48:51], v152 offset:4096
    ds_read_b128 v[52:55], v153 offset:4096
    ds_read_b128 v[56:59], v154 offset:4096
    ds_read_b128 v[60:63], v155 offset:4096
    s_waitcnt lgkmcnt(7)
    v_mfma_f32_16x16x32_bf16 v[128:131], v[32:35], v[16:19], 0
    s_waitcnt lgkmcnt(6)
    v_mfma_f32_16x16x32_bf16 v[128:131], v[36:39], v[20:23], v[128:131]
    s_waitcnt lgkmcnt(5)
    v_mfma_f32_16x16x32_bf16 v[128:131], v[40:43], v[24:27], v[128:131]
    s_waitcnt lgkmcnt(4)
    v_mfma_f32_16x16x32_bf16 v[128:131], v[44:47], v[28:31], v[128:131]
    s_waitcnt lgkmcnt(3)
    v_mfma_f32_16x16x32_bf16 v[132:135], v[48:51], v[16:19], 0
    s_waitcnt lgkmcnt(2)
    v_mfma_f32_16x16x32_bf16 v[132:135], v[52:55], v[20:23], v[132:135]
    s_waitcnt lgkmcnt(1)
    v_mfma_f32_16x16x32_bf16 v[132:135], v[56:59], v[24:27], v[132:135]
    s_waitcnt lgkmcnt(0)
    v_mfma_f32_16x16x32_bf16 v[132:135], v[60:63], v[28:31], v[132:135]
    s_nop 7
    v_cvt_pk_bf16_f32 v166, v128, v129
    v_cvt_pk_bf16_f32 v167, v130, v131
    v_cvt_pk_bf16_f32 v168, v132, v133
    v_cvt_pk_bf16_f32 v169, v134, v135
    v_lshlrev_b32 v128, 16, v166
    v_and_b32 v129, 0xffff0000, v166
    v_lshlrev_b32 v130, 16, v167
    v_and_b32 v131, 0xffff0000, v167
    v_lshlrev_b32 v132, 16, v168
    v_and_b32 v133, 0xffff0000, v168
    v_lshlrev_b32 v134, 16, v169
    v_and_b32 v135, 0xffff0000, v169
    v_mul_f32 v128, 0x3db504f3, v128
    v_mul_f32 v129, 0x3db504f3, v129
    v_mul_f32 v130, 0x3db504f3, v130
    v_mul_f32 v131, 0x3db504f3, v131
    v_mul_f32 v132, 0x3db504f3, v132
    v_mul_f32 v133, 0x3db504f3, v133
    v_mul_f32 v134, 0x3db504f3, v134
    v_mul_f32 v135, 0x3db504f3, v135
    v_cvt_pk_bf16_f32 v166, v128, v129
    v_cvt_pk_bf16_f32 v167, v130, v131
    v_cvt_pk_bf16_f32 v168, v132, v133
    v_cvt_pk_bf16_f32 v169, v134, v135
    v_lshlrev_b32 v128, 16, v166
    v_and_b32 v129, 0xffff0000, v166
    v_lshlrev_b32 v130, 16, v167
    v_and_b32 v131, 0xffff0000, v167
    v_lshlrev_b32 v132, 16, v168
    v_and_b32 v133, 0xffff0000, v168
    v_lshlrev_b32 v134, 16, v169
    v_and_b32 v135, 0xffff0000, v169
    v_mul_f32 v128, 0x3fb8aa3b, v128
    v_mul_f32 v129, 0x3fb8aa3b, v129
    v_mul_f32 v130, 0x3fb8aa3b, v130
    v_mul_f32 v131, 0x3fb8aa3b, v131
    v_mul_f32 v132, 0x3fb8aa3b, v132
    v_mul_f32 v133, 0x3fb8aa3b, v133
    v_mul_f32 v134, 0x3fb8aa3b, v134
    v_mul_f32 v135, 0x3fb8aa3b, v135
    v_max3_f32 v166, v128, v129, v130
    v_max3_f32 v167, v131, v132, v133
    v_max3_f32 v166, v166, v134, v135
    v_max_f32 v166, v166, v167
    v_cmp_gt_f32 vcc, v166, v164
    s_cbranch_vccz L_nomax
    v_mov_b32 v167, v166
    s_nop 1
    v_permlane16_swap_b32 v167, v166
    s_nop 0
    v_max_f32 v166, v167, v166
    v_mov_b32 v167, v166
    s_nop 1
    v_permlane32_swap_b32 v167, v166
    s_nop 0
    v_max_f32 v166, v167, v166
    v_max_f32 v166, v166, v164
    v_sub_f32 v167, v164, v166
    v_exp_f32 v167, v167
    v_mov_b32 v164, v166
    v_mul_f32 v172, v172, v167
    v_pk_mul_f32 v[96:97], v[96:97], v[166:167] op_sel:[0,1] op_sel_hi:[1,1]
    v_pk_mul_f32 v[98:99], v[98:99], v[166:167] op_sel:[0,1] op_sel_hi:[1,1]
    v_pk_mul_f32 v[100:101], v[100:101], v[166:167] op_sel:[0,1] op_sel_hi:[1,1]
    v_pk_mul_f32 v[102:103], v[102:103], v[166:167] op_sel:[0,1] op_sel_hi:[1,1]
    v_pk_mul_f32 v[104:105], v[104:105], v[166:167] op_sel:[0,1] op_sel_hi:[1,1]
    v_pk_mul_f32 v[106:107], v[106:107], v[166:167] op_sel:[0,1] op_sel_hi:[1,1]
    v_pk_mul_f32 v[108:109], v[108:109], v[166:167] op_sel:[0,1] op_sel_hi:[1,1]
    v_pk_mul_f32 v[110:111], v[110:111], v[166:167] op_sel:[0,1] op_sel_hi:[1,1]
    v_pk_mul_f32 v[112:113], v[112:113], v[166:167] op_sel:[0,1] op_sel_hi:[1,1]
    v_pk_mul_f32 v[114:115], v[114:115], v[166:167] op_sel:[0,1] op_sel_hi:[1,1]
    v_pk_mul_f32 v[116:117], v[116:117], v[166:167] op_sel:[0,1] op_sel_hi:[1,1]
    v_pk_mul_f32 v[118:119], v[118:119], v[166:167] op_sel:[0,1] op_sel_hi:[1,1]
    v_pk_mul_f32 v[120:121], v[120:121], v[166:167] op_sel:[0,1] op_sel_hi:[1,1]
    v_pk_mul_f32 v[122:123], v[122:123], v[166:167] op_sel:[0,1] op_sel_hi:[1,1]
    v_pk_mul_f32 v[124:125], v[124:125], v[166:167] op_sel:[0,1] op_sel_hi:[1,1]
    v_pk_mul_f32 v[126:127], v[126:127], v[166:167] op_sel:[0,1] op_sel_hi:[1,1]
L_nomax:
    v_sub_f32 v128, v128, v164
    v_sub_f32 v129, v129, v164
    v_sub_f32 v130, v130, v164
    v_sub_f32 v131, v131, v164
    v_sub_f32 v132, v132, v164
    v_sub_f32 v133, v133, v164
    v_sub_f32 v134, v134, v164
    v_sub_f32 v135, v135, v164
    v_exp_f32 v128, v128
    v_exp_f32 v129, v129
    v_exp_f32 v130, v130
    v_exp_f32 v131, v131
    v_exp_f32 v132, v132
    v_exp_f32 v133, v133
    v_exp_f32 v134, v134
    v_exp_f32 v135, v135
    s_nop 0
    v_cvt_pk_bf16_f32 v136, v128, v129
    v_cvt_pk_bf16_f32 v137, v130, v131
    v_cvt_pk_bf16_f32 v138, v132, v133
    v_cvt_pk_bf16_f32 v139, v134, v135
    s_nop 1
    v_mfma_f32_16x16x32_bf16 v[172:175], v[176:179], v[136:139], v[172:175]
    s_add_u32 s26, s26, 1
    s_mov_b32 s21, 4194304
L_spin_21:
    ds_read_b32 v3, v2
    s_waitcnt lgkmcnt(0)
    v_readfirstlane_b32 s20, v3
    s_cmp_ge_i32 s20, s26
    s_cbranch_scc1 L_spinx_22
    s_sub_u32 s21, s21, 1
    s_cmp_lg_u32 s21, 0
    s_cbranch_scc1 L_spin_21
    s_branch L_end
L_spinx_22:
    ds_read_b64_tr_b16 v[64:65], v156
    ds_read_b64_tr_b16 v[66:67], v156 offset:4096
    ds_read_b64_tr_b16 v[68:69], v157
    ds_read_b64_tr_b16 v[70:71], v157 offset:4096
    ds_read_b64_tr_b16 v[72:73], v158
    ds_read_b64_tr_b16 v[74:75], v158 offset:4096
    ds_read_b64_tr_b16 v[76:77], v159
    ds_read_b64_tr_b16 v[78:79], v159 offset:4096
    s_waitcnt lgkmcnt(4)
    ds_read_b64_tr_b16 v[80:81], v160
    ds_read_b64_tr_b16 v[82:83], v160 offset:4096
    ds_read_b64_tr_b16 v[84:85], v161
    ds_read_b64_tr_b16 v[86:87], v161 offset:4096
    ds_read_b64_tr_b16 v[88:89], v162
    ds_read_b64_tr_b16 v[90:91], v162 offset:4096
    ds_read_b64_tr_b16 v[92:93], v163
    ds_read_b64_tr_b16 v[94:95], v163 offset:4096
    s_waitcnt lgkmcnt(8)
    v_mfma_f32_16x16x32_bf16 v[96:99], v[64:67], v[136:139], v[96:99]
    v_mfma_f32_16x16x32_bf16 v[100:103], v[68:71], v[136:139], v[100:103]
    v_mfma_f32_16x16x32_bf16 v[104:107], v[72:75], v[136:139], v[104:107]
    v_mfma_f32_16x16x32_bf16 v[108:111], v[76:79], v[136:139], v[108:111]
    s_waitcnt lgkmcnt(0)
    s_lshr_b32 s26, s25, 12
    s_add_u32 s26, s26, 155664
    v_mov_b32 v166, s26
    s_add_u32 s26, s24, 6
    v_mov_b32 v167, s26
    ds_write_b32 v166, v167
    ds_read_b32 v7, v197
    v_mfma_f32_16x16x32_bf16 v[112:115], v[80:83], v[136:139], v[112:115]
    v_mfma_f32_16x16x32_bf16 v[116:119], v[84:87], v[136:139], v[116:119]
    v_mfma_f32_16x16x32_bf16 v[120:123], v[88:91], v[136:139], v[120:123]
    v_mfma_f32_16x16x32_bf16 v[124:127], v[92:95], v[136:139], v[124:127]
    s_add_u32 s24, s24, 4
    s_add_u32 s25, s25, 65536
    s_cmp_ge_u32 s25, 98304
    s_cselect_b32 s26, 98304, 0
    s_sub_u32 s25, s25, s26
    s_waitcnt lgkmcnt(0)
    v_readfirstlane_b32 s22, v7
    s_cmp_ge_i32 s24, s22
    s_cbranch_scc0 L_chunk
L_attn_done:
    v_mov_b32 v165, v172
    s_mov_b32 s22, 0x000f000f
    s_mov_b32 s23, 0x000f000f
    s_nop 1
    s_mov_b64 exec, s[22:23]
    ds_write_b128 v181, v[96:99] offset:0
    ds_write_b128 v181, v[100:103] offset:64
    ds_write_b128 v181, v[104:107] offset:128
    ds_write_b128 v181, v[108:111] offset:192
    ds_write_b128 v181, v[112:115] offset:256
    ds_write_b128 v181, v[116:119] offset:320
    ds_write_b128 v181, v[120:123] offset:384
    ds_write_b128 v181, v[124:127] offset:448
    s_mov_b64 exec, 0xf
    ds_write_b64 v180, v[164:165]
    s_waitcnt lgkmcnt(0)
    s_mov_b64 exec, 1
    ds_add_u32 v194, v196
    s_mov_b64 exec, -1
    s_mov_b64 s[72:73], -1
    s_mov_b64 s[74:75], -1
    s_mov_b64 s[76:77], -1
    s_mov_b64 s[78:79], -1
    s_mov_b64 s[80:81], -1
    s_mov_b64 s[82:83], -1
    s_mov_b64 s[84:85], -1
    s_mov_b64 s[86:87], -1
    s_mov_b32 s21, 4194304
L_spin_23:
    ds_read_b32 v3, v194
    s_waitcnt lgkmcnt(0)
    v_readfirstlane_b32 s20, v3
    s_cmp_ge_i32 s20, 4
    s_cbranch_scc1 L_spinx_24
    s_sub_u32 s21, s21, 1
    s_cmp_lg_u32 s21, 0
    s_cbranch_scc1 L_spin_23
    s_branch L_end
L_spinx_24:
    ds_read_b64 v[16:17], v182 offset:0
    ds_read_b64 v[18:19], v182 offset:32
    ds_read_b64 v[20:21], v182 offset:64
    ds_read_b64 v[22:23], v182 offset:96
    ds_read_b128 v[32:35], v183
    ds_read_b128 v[36:39], v184
    ds_read_b128 v[40:43], v185
    ds_read_b128 v[44:47], v186
    s_waitcnt lgkmcnt(4)
    v_max3_f32 v50, v16, v18, v20
    v_max_f32 v50, v50, v22
    v_sub_f32 v26, v16, v50
    v_sub_f32 v27, v18, v50
    v_sub_f32 v28, v20, v50
    v_sub_f32 v29, v22, v50
    v_exp_f32 v26, v26
    v_exp_f32 v27, v27
    v_exp_f32 v28, v28
    v_exp_f32 v29, v29
    s_waitcnt lgkmcnt(0)
    v_pk_mul_f32 v[52:53], v[32:33], v[26:27] op_sel:[0,0] op_sel_hi:[1,0]
    v_pk_mul_f32 v[54:55], v[34:35], v[26:27] op_sel:[0,0] op_sel_hi:[1,0]
    v_mul_f32 v51, v26, v17
    v_pk_fma_f32 v[52:53], v[36:37], v[26:27], v[52:53] op_sel:[0,1,0] op_sel_hi:[1,1,1]
    v_pk_fma_f32 v[54:55], v[38:39], v[26:27], v[54:55] op_sel:[0,1,0] op_sel_hi:[1,1,1]
    v_fmac_f32 v51, v27, v19
    v_pk_fma_f32 v[52:53], v[40:41], v[28:29], v[52:53] op_sel:[0,0,0] op_sel_hi:[1,0,1]
    v_pk_fma_f32 v[54:55], v[42:43], v[28:29], v[54:55] op_sel:[0,0,0] op_sel_hi:[1,0,1]
    v_fmac_f32 v51, v28, v21
    v_pk_fma_f32 v[52:53], v[44:45], v[28:29], v[52:53] op_sel:[0,1,0] op_sel_hi:[1,1,1]
    v_pk_fma_f32 v[54:55], v[46:47], v[28:29], v[54:55] op_sel:[0,1,0] op_sel_hi:[1,1,1]
    v_fmac_f32 v51, v29, v23
    v_cvt_pk_bf16_f32 v48, v52, v53
    v_cvt_pk_bf16_f32 v49, v54, v55
    s_mov_b32 exec_hi, 0
    buffer_store_dwordx4 v[48:51], v187, s[8:11], s65 offen sc1
    s_mov_b64 exec, -1
    v_mov_b32 v2, 155752
    s_mov_b64 exec, 1
    ds_add_u32 v2, v196
    s_mov_b64 exec, -1
    s_cmp_eq_u32 s67, 1
    s_cbranch_scc0 L_ffn
    s_mov_b32 s29, 131072
    buffer_load_dwordx4 v[32:35], v188, s[8:11], s66 offen offset:0 sc1
    buffer_load_dwordx4 v[36:39], v188, s[8:11], s66 offen offset:2048 sc1
    buffer_load_dwordx4 v[40:43], v189, s[8:11], s66 offen offset:0 sc1
    buffer_load_dwordx4 v[44:47], v189, s[8:11], s66 offen offset:2048 sc1
    buffer_load_dwordx4 v[48:51], v190, s[8:11], s66 offen offset:0 sc1
    buffer_load_dwordx4 v[52:55], v190, s[8:11], s66 offen offset:2048 sc1
    buffer_load_dwordx4 v[56:59], v191, s[8:11], s66 offen offset:0 sc1
    buffer_load_dwordx4 v[60:63], v191, s[8:11], s66 offen offset:2048 sc1
    v_mov_b32 v2, 155724
    s_mov_b32 s21, 4194304
L_spin_25:
    ds_read_b32 v3, v2
    s_waitcnt lgkmcnt(0)
    v_readfirstlane_b32 s20, v3
    s_cmp_ge_i32 s20, 1
    s_cbranch_scc1 L_spinx_26
    s_sub_u32 s21, s21, 1
    s_cmp_lg_u32 s21, 0
    s_cbranch_scc1 L_spin_25
    s_branch L_end
L_spinx_26:
    ds_read_b64_tr_b16 v[128:129], v193 offset:0
    ds_read_b64_tr_b16 v[130:131], v193 offset:512
    ds_read_b64_tr_b16 v[132:133], v193 offset:4096
    ds_read_b64_tr_b16 v[134:135], v193 offset:4608
    ds_read_b64_tr_b16 v[136:137], v193 offset:8192
    ds_read_b64_tr_b16 v[138:139], v193 offset:8704
    ds_read_b64_tr_b16 v[140:141], v193 offset:12288
    ds_read_b64_tr_b16 v[142:143], v193 offset:12800
    s_waitcnt lgkmcnt(4)
    ds_read_b64_tr_b16 v[144:145], v193 offset:16384
    ds_read_b64_tr_b16 v[146:147], v193 offset:16896
    ds_read_b64_tr_b16 v[148:149], v193 offset:20480
    ds_read_b64_tr_b16 v[150:151], v193 offset:20992
    ds_read_b64_tr_b16 v[152:153], v193 offset:24576
    ds_read_b64_tr_b16 v[154:155], v193 offset:25088
    ds_read_b64_tr_b16 v[156:157], v193 offset:28672
    ds_read_b64_tr_b16 v[158:159], v193 offset:29184
    s_branch L_h1wait
L_h1poll:
    s_mov_b64 exec, s[72:73]
    s_cbranch_execz L_sk_27
    buffer_load_dwordx4 v[32:35], v188, s[8:11], s66 offen offset:0 sc1
L_sk_27:
    s_mov_b64 exec, s[74:75]
    s_cbranch_execz L_sk_28
    buffer_load_dwordx4 v[36:39], v188, s[8:11], s66 offen offset:2048 sc1
L_sk_28:
    s_mov_b64 exec, s[76:77]
    s_cbranch_execz L_sk_29
    buffer_load_dwordx4 v[40:43], v189, s[8:11], s66 offen offset:0 sc1
L_sk_29:
    s_mov_b64 exec, s[78:79]
    s_cbranch_execz L_sk_30
    buffer_load_dwordx4 v[44:47], v189, s[8:11], s66 offen offset:2048 sc1
L_sk_30:
    s_mov_b64 exec, s[80:81]
    s_cbranch_execz L_sk_31
    buffer_load_dwordx4 v[48:51], v190, s[8:11], s66 offen offset:0 sc1
L_sk_31:
    s_mov_b64 exec, s[82:83]
    s_cbranch_execz L_sk_32
    buffer_load_dwordx4 v[52:55], v190, s[8:11], s66 offen offset:2048 sc1
L_sk_32:
    s_mov_b64 exec, s[84:85]
    s_cbranch_execz L_sk_33
    buffer_load_dwordx4 v[56:59], v191, s[8:11], s66 offen offset:0 sc1
L_sk_33:
    s_mov_b64 exec, s[86:87]
    s_cbranch_execz L_sk_34
    buffer_load_dwordx4 v[60:63], v191, s[8:11], s66 offen offset:2048 sc1
L_sk_34:
L_h1wait:
    s_mov_b64 exec, -1
    s_mov_b64 s[26:27], 0
    s_waitcnt vmcnt(0)
    s_cmp_eq_u64 s[72:73], 0
    s_cbranch_scc1 L_sc_35
    v_max3_u32 v64, v32, v33, v34
    v_max_u32 v64, v64, v35
    v_cmp_eq_u32 vcc, -1, v64
    s_mov_b64 s[72:73], vcc
    s_or_b64 s[26:27], s[26:27], vcc
L_sc_35:
    s_cmp_eq_u64 s[74:75], 0
    s_cbranch_scc1 L_sc_36
    v_max3_u32 v64, v36, v37, v38
    v_max_u32 v64, v64, v39
    v_cmp_eq_u32 vcc, -1, v64
    s_mov_b64 s[74:75], vcc
    s_or_b64 s[26:27], s[26:27], vcc
L_sc_36:
    s_cmp_eq_u64 s[76:77], 0
    s_cbranch_scc1 L_sc_37
    v_max3_u32 v64, v40, v41, v42
    v_max_u32 v64, v64, v43
    v_cmp_eq_u32 vcc, -1, v64
    s_mov_b64 s[76:77], vcc
    s_or_b64 s[26:27], s[26:27], vcc
L_sc_37:
    s_cmp_eq_u64 s[78:79], 0
    s_cbranch_scc1 L_sc_38
    v_max3_u32 v64, v44, v45, v46
    v_max_u32 v64, v64, v47
    v_cmp_eq_u32 vcc, -1, v64
    s_mov_b64 s[78:79], vcc
    s_or_b64 s[26:27], s[26:27], vcc
L_sc_38:
    s_cmp_eq_u64 s[80:81], 0
    s_cbranch_scc1 L_sc_39
    v_max3_u32 v64, v48, v49, v50
    v_max_u32 v64, v64, v51
    v_cmp_eq_u32 vcc, -1, v64
    s_mov_b64 s[80:81], vcc
    s_or_b64 s[26:27], s[26:27], vcc
L_sc_39:
    s_cmp_eq_u64 s[82:83], 0
    s_cbranch_scc1 L_sc_40
    v_max3_u32 v64, v52, v53, v54
    v_max_u32 v64, v64, v55
    v_cmp_eq_u32 vcc, -1, v64
    s_mov_b64 s[82:83], vcc
    s_or_b64 s[26:27], s[26:27], vcc
L_sc_40:
    s_cmp_eq_u64 s[84:85], 0
    s_cbranch_scc1 L_sc_41
    v_max3_u32 v64, v56, v57, v58
    v_max_u32 v64, v64, v59
    v_cmp_eq_u32 vcc, -1, v64
    s_mov_b64 s[84:85], vcc
    s_or_b64 s[26:27], s[26:27], vcc
L_sc_41:
    s_cmp_eq_u64 s[86:87], 0
    s_cbranch_scc1 L_sc_42
    v_max3_u32 v64, v60, v61, v62
    v_max_u32 v64, v64, v63
    v_cmp_eq_u32 vcc, -1, v64
    s_mov_b64 s[86:87], vcc
    s_or_b64 s[26:27], s[26:27], vcc
L_sc_42:
    s_cmp_eq_u64 s[26:27], 0
    s_cbranch_scc1 L_h1got
    s_sub_u32 s29, s29, 1
    s_cmp_lg_u32 s29, 0
    s_cbranch_scc1 L_h1poll
    s_branch L_end
L_h1got:
    v_max3_f32 v64, v34, v38, v42
    v_max3_f32 v65, v46, v50, v54
    v_max3_f32 v64, v64, v58, v62
    v_max_f32 v64, v64, v65
    v_mov_b32 v72, v64
    v_mov_b32 v73, v64
    v_sub_f32 v16, v34, v64
    v_sub_f32 v17, v38, v64
    v_sub_f32 v18, v42, v64
    v_sub_f32 v19, v46, v64
    v_sub_f32 v20, v50, v64
    v_sub_f32 v21, v54, v64
    v_sub_f32 v22, v58, v64
    v_sub_f32 v23, v62, v64
    v_permlane16_swap_b32 v73, v72
    v_exp_f32 v16, v16
    v_exp_f32 v17, v17
    v_exp_f32 v18, v18
    v_exp_f32 v19, v19
    v_exp_f32 v20, v20
    v_exp_f32 v21, v21
    v_exp_f32 v22, v22
    v_exp_f32 v23, v23
    v_max_f32 v72, v73, v72
    v_lshlrev_b32 v80, 16, v32
    v_and_b32 v81, 0xffff0000, v32
    v_lshlrev_b32 v82, 16, v33
    v_and_b32 v83, 0xffff0000, v33
    v_mov_b32 v73, v72
    v_lshlrev_b32 v84, 16, v36
    v_and_b32 v85, 0xffff0000, v36
    v_lshlrev_b32 v86, 16, v37
    v_and_b32 v87, 0xffff0000, v37
    v_permlane32_swap_b32 v73, v72
    v_lshlrev_b32 v88, 16, v40
    v_and_b32 v89, 0xffff0000, v40
    v_lshlrev_b32 v90, 16, v41
    v_and_b32 v91, 0xffff0000, v41
    v_max_f32 v72, v73, v72
    v_lshlrev_b32 v92, 16, v44
    v_and_b32 v93, 0xffff0000, v44
    v_lshlrev_b32 v94, 16, v45
    v_and_b32 v95, 0xffff0000, v45
    v_sub_f32 v73, v64, v72
    v_lshlrev_b32 v96, 16, v48
    v_and_b32 v97, 0xffff0000, v48
    v_lshlrev_b32 v98, 16, v49
    v_and_b32 v99, 0xffff0000, v49
    v_exp_f32 v73, v73
    v_lshlrev_b32 v100, 16, v52
    v_and_b32 v101, 0xffff0000, v52
    v_lshlrev_b32 v102, 16, v53
    v_and_b32 v103, 0xffff0000, v53
    v_lshlrev_b32 v104, 16, v56
    v_and_b32 v105, 0xffff0000, v56
    v_lshlrev_b32 v106, 16, v57
    v_and_b32 v107, 0xffff0000, v57
    v_lshlrev_b32 v108, 16, v60
    v_and_b32 v109, 0xffff0000, v60
    v_lshlrev_b32 v110, 16, v61
    v_and_b32 v111, 0xffff0000, v61
    v_mul_f32 v65, v16, v35
    v_pk_mul_f32 v[68:69], v[80:81], v[16:17] op_sel:[0,0] op_sel_hi:[1,0]
    v_pk_mul_f32 v[70:71], v[82:83], v[16:17] op_sel:[0,0] op_sel_hi:[1,0]
    v_fmac_f32 v65, v17, v39
    v_pk_fma_f32 v[68:69], v[84:85], v[16:17], v[68:69] op_sel:[0,1,0] op_sel_hi:[1,1,1]
    v_pk_fma_f32 v[70:71], v[86:87], v[16:17], v[70:71] op_sel:[0,1,0] op_sel_hi:[1,1,1]
    v_fmac_f32 v65, v18, v43
    v_pk_fma_f32 v[68:69], v[88:89], v[18:19], v[68:69] op_sel:[0,0,0] op_sel_hi:[1,0,1]
    v_pk_fma_f32 v[70:71], v[90:91], v[18:19], v[70:71] op_sel:[0,0,0] op_sel_hi:[1,0,1]
    v_fmac_f32 v65, v19, v47
    v_pk_fma_f32 v[68:69], v[92:93], v[18:19], v[68:69] op_sel:[0,1,0] op_sel_hi:[1,1,1]
    v_pk_fma_f32 v[70:71], v[94:95], v[18:19], v[70:71] op_sel:[0,1,0] op_sel_hi:[1,1,1]
    v_fmac_f32 v65, v20, v51
    v_pk_fma_f32 v[68:69], v[96:97], v[20:21], v[68:69] op_sel:[0,0,0] op_sel_hi:[1,0,1]
    v_pk_fma_f32 v[70:71], v[98:99], v[20:21], v[70:71] op_sel:[0,0,0] op_sel_hi:[1,0,1]
    v_fmac_f32 v65, v21, v55
    v_pk_fma_f32 v[68:69], v[100:101], v[20:21], v[68:69] op_sel:[0,1,0] op_sel_hi:[1,1,1]
    v_pk_fma_f32 v[70:71], v[102:103], v[20:21], v[70:71] op_sel:[0,1,0] op_sel_hi:[1,1,1]
    v_fmac_f32 v65, v22, v59
    v_pk_fma_f32 v[68:69], v[104:105], v[22:23], v[68:69] op_sel:[0,0,0] op_sel_hi:[1,0,1]
    v_pk_fma_f32 v[70:71], v[106:107], v[22:23], v[70:71] op_sel:[0,0,0] op_sel_hi:[1,0,1]
    v_fmac_f32 v65, v23, v63
    v_pk_fma_f32 v[68:69], v[108:109], v[22:23], v[68:69] op_sel:[0,1,0] op_sel_hi:[1,1,1]
    v_pk_fma_f32 v[70:71], v[110:111], v[22:23], v[70:71] op_sel:[0,1,0] op_sel_hi:[1,1,1]
    v_pk_mul_f32 v[68:69], v[68:69], v[72:73] op_sel:[0,1] op_sel_hi:[1,1]
    v_pk_mul_f32 v[70:71], v[70:71], v[72:73] op_sel:[0,1] op_sel_hi:[1,1]
    v_mul_f32 v65, v65, v73
    v_mov_b32 v74, v68
    v_mov_b32 v75, v69
    v_mov_b32 v76, v70
    v_mov_b32 v77, v71
    v_mov_b32 v78, v65
    s_nop 0
    v_permlane16_swap_b32 v74, v68
    v_permlane16_swap_b32 v75, v69
    v_permlane16_swap_b32 v76, v70
    v_permlane16_swap_b32 v77, v71
    v_permlane16_swap_b32 v78, v65
    s_nop 0
    v_pk_add_f32 v[68:69], v[74:75], v[68:69]
    v_pk_add_f32 v[70:71], v[76:77], v[70:71]
    v_add_f32 v65, v78, v65
    v_mov_b32 v74, v68
    v_mov_b32 v75, v69
    v_mov_b32 v76, v70
    v_mov_b32 v77, v71
    v_mov_b32 v78, v65
    s_nop 0
    v_permlane32_swap_b32 v74, v68
    v_permlane32_swap_b32 v75, v69
    v_permlane32_swap_b32 v76, v70
    v_permlane32_swap_b32 v77, v71
    v_permlane32_swap_b32 v78, v65
    s_nop 0
    v_pk_add_f32 v[68:69], v[74:75], v[68:69]
    v_pk_add_f32 v[70:71], v[76:77], v[70:71]
    v_add_f32 v65, v78, v65
    v_rcp_f32 v72, v65
    s_nop 0
    v_fma_f32 v73, -v65, v72, 1.0
    v_fma_f32 v72, v72, v73, v72
    v_pk_mul_f32 v[68:69], v[68:69], v[72:73] op_sel:[0,0] op_sel_hi:[1,0]
    v_pk_mul_f32 v[70:71], v[70:71], v[72:73] op_sel:[0,0] op_sel_hi:[1,0]
    v_cvt_pk_bf16_f32 v68, v68, v69
    v_cvt_pk_bf16_f32 v69, v70, v71
    s_mov_b64 exec, 0xffff
    ds_write_b64 v192, v[68:69]
    s_mov_b64 exec, -1
    s_waitcnt lgkmcnt(0)
    s_barrier
    ds_read_b128 v[32:35], v195 offset:0
    ds_read_b128 v[36:39], v195 offset:64
    ds_read_b128 v[40:43], v195 offset:128
    ds_read_b128 v[44:47], v195 offset:192
    ds_read_b128 v[48:51], v195 offset:256
    ds_read_b128 v[52:55], v195 offset:320
    ds_read_b128 v[56:59], v195 offset:384
    ds_read_b128 v[60:63], v195 offset:448
    s_waitcnt lgkmcnt(7)
    v_mfma_f32_16x16x32_bf16 v[16:19], v[128:131], v[32:35], 0
    s_waitcnt lgkmcnt(6)
    v_mfma_f32_16x16x32_bf16 v[20:23], v[132:135], v[36:39], 0
    s_waitcnt lgkmcnt(5)
    v_mfma_f32_16x16x32_bf16 v[16:19], v[136:139], v[40:43], v[16:19]
    s_waitcnt lgkmcnt(4)
    v_mfma_f32_16x16x32_bf16 v[20:23], v[140:143], v[44:47], v[20:23]
    s_waitcnt lgkmcnt(3)
    v_mfma_f32_16x16x32_bf16 v[16:19], v[144:147], v[48:51], v[16:19]
    s_waitcnt lgkmcnt(2)
    v_mfma_f32_16x16x32_bf16 v[20:23], v[148:151], v[52:55], v[20:23]
    s_waitcnt lgkmcnt(1)
    v_mfma_f32_16x16x32_bf16 v[16:19], v[152:155], v[56:59], v[16:19]
    s_waitcnt lgkmcnt(0)
    v_mfma_f32_16x16x32_bf16 v[20:23], v[156:159], v[60:63], v[20:23]
    s_nop 7
    v_pk_add_f32 v[16:17], v[16:17], v[20:21]
    v_pk_add_f32 v[18:19], v[18:19], v[22:23]
    ds_bpermute_b32 v24, v198, v16
    ds_bpermute_b32 v25, v198, v17
    ds_bpermute_b32 v26, v198, v18
    ds_bpermute_b32 v27, v198, v19
    s_waitcnt lgkmcnt(0)
    s_mov_b32 exec_hi, 0
    buffer_store_dwordx4 v[24:27], v199, s[8:11], s35 offen sc1
    s_mov_b64 exec, -1
    s_branch L_fin
L_ffn:
    s_cmp_lt_i32 s63, 0
    s_cbranch_scc1 L_fin
    v_mov_b32 v2, 155724
    s_mov_b32 s21, 4194304
L_spin_43:
    ds_read_b32 v3, v2
    s_waitcnt lgkmcnt(0)
    v_readfirstlane_b32 s20, v3
    s_cmp_ge_i32 s20, 3
    s_cbranch_scc1 L_spinx_44
    s_sub_u32 s21, s21, 1
    s_cmp_lg_u32 s21, 0
    s_cbranch_scc1 L_spin_43
    s_branch L_end
L_spinx_44:
    v_bfe_u32 v6, v0, 2, 2
    v_lshl_add_u32 v6, v4, 3, v6
    v_lshlrev_b32 v6, 5, v6
    v_and_b32 v7, 3, v0
    v_lshl_add_u32 v6, v7, 3, v6
    s_lshl_b32 s20, s3, 12
    s_add_u32 s21, s20, 114688
    v_add_u32 v12, s21, v6
    s_add_u32 s21, s20, 131072
    v_add_u32 v13, s21, v6
    ds_read_b64_tr_b16 v[96:97], v12 offset:0
    ds_read_b64_tr_b16 v[98:99], v12 offset:128
    ds_read_b64_tr_b16 v[100:101], v12 offset:1024
    ds_read_b64_tr_b16 v[102:103], v12 offset:1152
    ds_read_b64_tr_b16 v[104:105], v12 offset:2048
    ds_read_b64_tr_b16 v[106:107], v12 offset:2176
    ds_read_b64_tr_b16 v[108:109], v12 offset:3072
    ds_read_b64_tr_b16 v[110:111], v12 offset:3200
    s_waitcnt lgkmcnt(4)
    ds_read_b64_tr_b16 v[112:113], v13 offset:0
    ds_read_b64_tr_b16 v[114:115], v13 offset:128
    ds_read_b64_tr_b16 v[116:117], v13 offset:1024
    ds_read_b64_tr_b16 v[118:119], v13 offset:1152
    ds_read_b64_tr_b16 v[120:121], v13 offset:2048
    ds_read_b64_tr_b16 v[122:123], v13 offset:2176
    ds_read_b64_tr_b16 v[124:125], v13 offset:3072
    ds_read_b64_tr_b16 v[126:127], v13 offset:3200
    v_lshrrev_b32 v6, 2, v0
    v_lshlrev_b32 v6, 10, v6
    v_and_b32 v7, 3, v0
    v_lshl_add_u32 v6, v7, 6, v6
    s_lshl_b32 s20, s3, 8
    s_add_u32 s20, s20, 0
    v_add_u32 v6, s20, v6
    s_waitcnt lgkmcnt(4)
    ds_read_b64_tr_b16 v[128:129], v6 offset:0
    ds_read_b64_tr_b16 v[130:131], v6 offset:8
    ds_read_b64_tr_b16 v[132:133], v6 offset:16
    ds_read_b64_tr_b16 v[134:135], v6 offset:24
    ds_read_b64_tr_b16 v[136:137], v6 offset:32
    ds_read_b64_tr_b16 v[138:139], v6 offset:40
    ds_read_b64_tr_b16 v[140:141], v6 offset:48
    ds_read_b64_tr_b16 v[142:143], v6 offset:56
    v_cmp_eq_u32 s[36:37], 0, v1
    v_cmp_eq_u32 s[38:39], 1, v1
    v_cmp_eq_u32 s[40:41], 2, v1
    v_cmp_eq_u32 s[42:43], 3, v1
    v_cmp_eq_u32 s[44:45], 4, v1
    v_cmp_eq_u32 s[46:47], 5, v1
    v_cmp_eq_u32 s[48:49], 6, v1
    v_cmp_eq_u32 s[50:51], 7, v1
    v_mov_b32 v5, 155720
    s_mov_b32 s21, 4194304
L_spin_45:
    ds_read_b32 v6, v5
    s_waitcnt lgkmcnt(0)
    v_readfirstlane_b32 s20, v6
    s_cmp_ge_i32 s20, 1
    s_cbranch_scc1 L_spinx_46
    s_sub_u32 s21, s21, 1
    s_cmp_lg_u32 s21, 0
    s_cbranch_scc1 L_spin_45
    s_branch L_end
L_spinx_46:
    s_and_b32 s20, s2, 7
    s_lshl_b32 s20, s20, 15
    s_lshl_b32 s21, s3, 9
    s_add_u32 s20, s20, s21
    s_add_u32 s20, s20, 393216
    v_and_b32 v6, 31, v0
    v_lshrrev_b32 v7, 5, v0
    v_lshlrev_b32 v5, 14, v7
    v_lshl_add_u32 v5, v6, 4, v5
    v_add_u32 v12, 4096, v5
    v_add_u32 v13, 8192, v5
    v_add_u32 v14, 12288, v5
    v_lshlrev_b32 v144, 16, v8
    v_and_b32 v145, 0xffff0000, v8
    v_lshlrev_b32 v146, 16, v9
    v_and_b32 v147, 0xffff0000, v9
    s_lshl_b32 s30, s3, 3
    s_add_u32 s30, s30, 158400
    v_mov_b32 v148, s30
    v_mov_b32 v149, 158400
    s_lshl_b32 s30, s3, 9
    s_add_u32 s30, s30, 159232
    v_lshl_add_u32 v150, v6, 4, s30
    s_lshl_b32 s30, s3, 8
    s_add_u32 s30, s30, 156160
    v_lshl_add_u32 v151, v6, 3, s30
    v_lshl_add_u32 v152, v4, 4, s30
    s_lshl_b32 s30, s3, 7
    s_add_u32 s30, s30, 158464
    v_lshl_add_u32 v153, v4, 4, s30
    v_lshlrev_b32 v154, 4, v4
    v_add_u32 v154, 158464, v154
    s_lshl_b32 s31, s63, 11
    s_lshl_b32 s21, s3, 9
    s_add_u32 s31, s31, s21
    s_add_u32 s31, s31, 655360
    v_lshlrev_b32 v157, 7, v4
    v_lshl_add_u32 v157, v1, 4, v157
    v_lshrrev_b32 v164, 2, v0
    v_lshlrev_b32 v164, 11, v164
    v_and_b32 v165, 3, v0
    v_lshl_add_u32 v164, v165, 4, v164
    s_lshl_b32 s30, s63, 6
    s_add_u32 s30, s30, 655360
    s_add_u32 s52, s30, 0
    s_add_u32 s53, s30, 32768
    s_add_u32 s56, s30, 65536
    s_add_u32 s57, s30, 98304
    s_add_u32 s61, s30, 131072
    s_add_u32 s62, s30, 163840
    s_add_u32 s64, s30, 196608
    s_lshl_b32 s30, s63, 6
    s_add_u32 s30, s30, 159232
    v_lshl_add_u32 v166, v165, 4, s30
    v_lshlrev_b32 v167, 3, v165
    s_lshl_b32 s65, s63, 5
    s_mov_b32 s12, s54
    s_and_b32 s13, s55, 0xffff
    s_mov_b32 s14, 0x400
    s_mov_b32 s15, 0x20000
    v_mov_b32 v158, 0x3d372713
    v_mov_b32 v160, 0x40135761
    v_mov_b32 v162, 1.0
    v_mov_b32 v163, 1.0
    s_mov_b64 s[72:73], -1
    s_mov_b64 s[74:75], -1
    s_mov_b64 s[76:77], -1
    s_mov_b64 s[78:79], -1
    s_mov_b64 s[80:81], -1
    s_mov_b64 s[82:83], -1
    s_mov_b64 s[84:85], -1
    s_mov_b64 s[86:87], -1
    s_mov_b32 s29, 131072
    buffer_load_dwordx4 v[32:35], v5, s[8:11], s20 offen offset:0 sc1
    buffer_load_dwordx4 v[36:39], v5, s[8:11], s20 offen offset:2048 sc1
    buffer_load_dwordx4 v[40:43], v12, s[8:11], s20 offen offset:0 sc1
    buffer_load_dwordx4 v[44:47], v12, s[8:11], s20 offen offset:2048 sc1
    buffer_load_dwordx4 v[48:51], v13, s[8:11], s20 offen offset:0 sc1
    buffer_load_dwordx4 v[52:55], v13, s[8:11], s20 offen offset:2048 sc1
    buffer_load_dwordx4 v[56:59], v14, s[8:11], s20 offen offset:0 sc1
    buffer_load_dwordx4 v[60:63], v14, s[8:11], s20 offen offset:2048 sc1
L_h2poll:
    s_mov_b64 s[26:27], 0
    s_waitcnt vmcnt(7)
    v_max3_u32 v64, v32, v33, v34
    v_max_u32 v64, v64, v35
    v_cmp_eq_u32 vcc, -1, v64
    s_and_b64 s[72:73], s[72:73], vcc
    s_or_b64 s[26:27], s[26:27], s[72:73]
    s_mov_b64 exec, s[72:73]
    buffer_load_dwordx4 v[32:35], v5, s[8:11], s20 offen offset:0 sc1
    s_mov_b64 exec, -1
    s_waitcnt vmcnt(7)
    v_max3_u32 v64, v36, v37, v38
    v_max_u32 v64, v64, v39
    v_cmp_eq_u32 vcc, -1, v64
    s_and_b64 s[74:75], s[74:75], vcc
    s_or_b64 s[26:27], s[26:27], s[74:75]
    s_mov_b64 exec, s[74:75]
    buffer_load_dwordx4 v[36:39], v5, s[8:11], s20 offen offset:2048 sc1
    s_mov_b64 exec, -1
    s_waitcnt vmcnt(7)
    v_max3_u32 v64, v40, v41, v42
    v_max_u32 v64, v64, v43
    v_cmp_eq_u32 vcc, -1, v64
    s_and_b64 s[76:77], s[76:77], vcc
    s_or_b64 s[26:27], s[26:27], s[76:77]
    s_mov_b64 exec, s[76:77]
    buffer_load_dwordx4 v[40:43], v12, s[8:11], s20 offen offset:0 sc1
    s_mov_b64 exec, -1
    s_waitcnt vmcnt(7)
    v_max3_u32 v64, v44, v45, v46
    v_max_u32 v64, v64, v47
    v_cmp_eq_u32 vcc, -1, v64
    s_and_b64 s[78:79], s[78:79], vcc
    s_or_b64 s[26:27], s[26:27], s[78:79]
    s_mov_b64 exec, s[78:79]
    buffer_load_dwordx4 v[44:47], v12, s[8:11], s20 offen offset:2048 sc1
    s_mov_b64 exec, -1
    s_waitcnt vmcnt(7)
    v_max3_u32 v64, v48, v49, v50
    v_max_u32 v64, v64, v51
    v_cmp_eq_u32 vcc, -1, v64
    s_and_b64 s[80:81], s[80:81], vcc
    s_or_b64 s[26:27], s[26:27], s[80:81]
    s_mov_b64 exec, s[80:81]
    buffer_load_dwordx4 v[48:51], v13, s[8:11], s20 offen offset:0 sc1
    s_mov_b64 exec, -1
    s_waitcnt vmcnt(7)
    v_max3_u32 v64, v52, v53, v54
    v_max_u32 v64, v64, v55
    v_cmp_eq_u32 vcc, -1, v64
    s_and_b64 s[82:83], s[82:83], vcc
    s_or_b64 s[26:27], s[26:27], s[82:83]
    s_mov_b64 exec, s[82:83]
    buffer_load_dwordx4 v[52:55], v13, s[8:11], s20 offen offset:2048 sc1
    s_mov_b64 exec, -1
    s_waitcnt vmcnt(7)
    v_max3_u32 v64, v56, v57, v58
    v_max_u32 v64, v64, v59
    v_cmp_eq_u32 vcc, -1, v64
    s_and_b64 s[84:85], s[84:85], vcc
    s_or_b64 s[26:27], s[26:27], s[84:85]
    s_mov_b64 exec, s[84:85]
    buffer_load_dwordx4 v[56:59], v14, s[8:11], s20 offen offset:0 sc1
    s_mov_b64 exec, -1
    s_waitcnt vmcnt(7)
    v_max3_u32 v64, v60, v61, v62
    v_max_u32 v64, v64, v63
    v_cmp_eq_u32 vcc, -1, v64
    s_and_b64 s[86:87], s[86:87], vcc
    s_or_b64 s[26:27], s[26:27], s[86:87]
    s_mov_b64 exec, s[86:87]
    buffer_load_dwordx4 v[60:63], v14, s[8:11], s20 offen offset:2048 sc1
    s_mov_b64 exec, -1
    s_cmp_eq_u64 s[26:27], 0
    s_cbranch_scc1 L_h2got
    s_sub_u32 s29, s29, 1
    s_cmp_lg_u32 s29, 0
    s_cbranch_scc1 L_h2poll
    s_branch L_end
L_h2got:
    s_cmp_eq_u32 s63, 0
    s_cbranch_scc0 L_noe
    s_cmp_eq_u32 s3, 1
    s_cbranch_scc0 L_noe
    s_add_u32 s60, s60, 0x9e3779b9
    v_mov_b32 v66, 0
    v_mov_b32 v67, s60
    s_mov_b64 exec, 1
    buffer_store_dword v67, v66, s[8:11], 0 offen sc1
    s_mov_b64 exec, -1
L_noe:
    v_pk_add_f32 v[32:33], v[32:33], v[36:37]
    v_pk_add_f32 v[40:41], v[40:41], v[44:45]
    v_pk_add_f32 v[48:49], v[48:49], v[52:53]
    v_pk_add_f32 v[56:57], v[56:57], v[60:61]
    v_pk_add_f32 v[34:35], v[34:35], v[38:39]
    v_pk_add_f32 v[42:43], v[42:43], v[46:47]
    v_pk_add_f32 v[50:51], v[50:51], v[54:55]
    v_pk_add_f32 v[58:59], v[58:59], v[62:63]
    v_pk_add_f32 v[32:33], v[32:33], v[40:41]
    v_pk_add_f32 v[48:49], v[48:49], v[56:57]
    v_pk_add_f32 v[34:35], v[34:35], v[42:43]
    v_pk_add_f32 v[50:51], v[50:51], v[58:59]
    v_pk_add_f32 v[32:33], v[32:33], v[48:49]
    v_pk_add_f32 v[34:35], v[34:35], v[50:51]
    v_mov_b32 v36, v32
    v_mov_b32 v37, v33
    v_mov_b32 v38, v34
    v_mov_b32 v39, v35
    s_nop 0
    v_permlane32_swap_b32 v36, v32
    v_permlane32_swap_b32 v37, v33
    v_permlane32_swap_b32 v38, v34
    v_permlane32_swap_b32 v39, v35
    s_nop 0
    v_pk_add_f32 v[32:33], v[36:37], v[32:33]
    v_pk_add_f32 v[34:35], v[38:39], v[34:35]
    v_cvt_pk_bf16_f32 v36, v32, v33
    v_cvt_pk_bf16_f32 v37, v34, v35
    v_lshlrev_b32 v32, 16, v36
    v_and_b32 v33, 0xffff0000, v36
    v_lshlrev_b32 v34, 16, v37
    v_and_b32 v35, 0xffff0000, v37
    v_pk_add_f32 v[32:33], v[144:145], v[32:33]
    v_pk_add_f32 v[34:35], v[146:147], v[34:35]
    v_cvt_pk_bf16_f32 v36, v32, v33
    v_cvt_pk_bf16_f32 v37, v34, v35
    v_lshlrev_b32 v16, 16, v36
    v_and_b32 v17, 0xffff0000, v36
    v_lshlrev_b32 v18, 16, v37
    v_and_b32 v19, 0xffff0000, v37
    v_pk_add_f32 v[24:25], v[16:17], v[18:19]
    v_pk_mul_f32 v[20:21], v[16:17], v[16:17]
    v_pk_mul_f32 v[22:23], v[18:19], v[18:19]
    s_mov_b32 exec_hi, 0
    ds_write_b128 v150, v[16:19]
    s_mov_b64 exec, -1
    v_pk_add_f32 v[20:21], v[20:21], v[22:23]
    v_add_f32 v24, v24, v25
    v_add_f32 v25, v20, v21
    s_nop 0
    v_add_f32_dpp v24, v24, v24 row_ror:8 row_mask:0xf bank_mask:0xf
    v_add_f32_dpp v25, v25, v25 row_ror:8 row_mask:0xf bank_mask:0xf
    s_nop 0
    v_add_f32_dpp v24, v24, v24 row_ror:4 row_mask:0xf bank_mask:0xf
    v_add_f32_dpp v25, v25, v25 row_ror:4 row_mask:0xf bank_mask:0xf
    s_nop 0
    v_add_f32_dpp v24, v24, v24 row_ror:2 row_mask:0xf bank_mask:0xf
    v_add_f32_dpp v25, v25, v25 row_ror:2 row_mask:0xf bank_mask:0xf
    s_nop 0
    v_add_f32_dpp v24, v24, v24 row_ror:1 row_mask:0xf bank_mask:0xf
    v_add_f32_dpp v25, v25, v25 row_ror:1 row_mask:0xf bank_mask:0xf
    s_nop 0
    v_add_f32_dpp v24, v24, v24 row_bcast:15 row_mask:0xa bank_mask:0xf
    v_add_f32_dpp v25, v25, v25 row_bcast:15 row_mask:0xa bank_mask:0xf
    s_nop 0
    v_readlane_b32 s23, v24, 31
    v_readlane_b32 s24, v25, 31
    s_nop 0
    v_mov_b32 v24, s23
    v_mov_b32 v25, s24
    s_mov_b64 exec, 1
    ds_write_b64 v148, v[24:25]
    s_mov_b64 exec, -1
    s_waitcnt lgkmcnt(0)
    s_barrier
    ds_read_b128 v[32:35], v149
    ds_read_b128 v[36:39], v149 offset:16
    s_mov_b32 s25, 0x3b000000
    s_waitcnt lgkmcnt(0)
    v_pk_add_f32 v[32:33], v[32:33], v[34:35]
    v_pk_add_f32 v[36:37], v[36:37], v[38:39]
    v_pk_add_f32 v[32:33], v[32:33], v[36:37]
    v_mul_f32 v24, s25, v32
    v_mul_f32 v25, s25, v33
    v_fma_f32 v25, -v24, v24, v25
    v_max_f32 v25, 0, v25
    v_cvt_pk_bf16_f32 v25, v25, v24
    v_and_b32 v26, 0xffff0000, v25
    v_lshlrev_b32 v25, 16, v25
    v_add_f32 v25, 0x3727c5ac, v25
    v_cvt_pk_bf16_f32 v25, v25, v25
    v_lshlrev_b32 v25, 16, v25
    v_sqrt_f32 v25, v25
    s_nop 0
    v_cvt_pk_bf16_f32 v25, v25, v25
    v_lshlrev_b32 v25, 16, v25
    v_rcp_f32 v27, v25
    s_nop 0
    v_fma_f32 v28, -v25, v27, 1.0
    v_fma_f32 v27, v27, v28, v27
    v_sub_f32 v20, v16, v26
    v_sub_f32 v21, v17, v26
    v_sub_f32 v22, v18, v26
    v_sub_f32 v23, v19, v26
    v_cvt_pk_bf16_f32 v40, v20, v21
    v_cvt_pk_bf16_f32 v41, v22, v23
    v_lshlrev_b32 v20, 16, v40
    v_and_b32 v21, 0xffff0000, v40
    v_lshlrev_b32 v22, 16, v41
    v_and_b32 v23, 0xffff0000, v41
    v_pk_mul_f32 v[20:21], v[20:21], v[26:27] op_sel:[0,1] op_sel_hi:[1,1]
    v_pk_mul_f32 v[22:23], v[22:23], v[26:27] op_sel:[0,1] op_sel_hi:[1,1]
    v_cvt_pk_bf16_f32 v40, v20, v21
    v_cvt_pk_bf16_f32 v41, v22, v23
    s_mov_b32 exec_hi, 0
    ds_write_b64 v151, v[40:41]
    s_mov_b64 exec, -1
    s_waitcnt lgkmcnt(0)
    ds_read_b128 v[48:51], v152 offset:0
    ds_read_b128 v[52:55], v152 offset:64
    ds_read_b128 v[56:59], v152 offset:128
    ds_read_b128 v[60:63], v152 offset:192
    s_waitcnt lgkmcnt(3)
    v_mfma_f32_16x16x32_bf16 v[16:19], v[96:99], v[48:51], 0
    v_mfma_f32_16x16x32_bf16 v[20:23], v[112:115], v[48:51], 0
    s_waitcnt lgkmcnt(2)
    v_mfma_f32_16x16x32_bf16 v[16:19], v[100:103], v[52:55], v[16:19]
    v_mfma_f32_16x16x32_bf16 v[20:23], v[116:119], v[52:55], v[20:23]
    s_waitcnt lgkmcnt(1)
    v_mfma_f32_16x16x32_bf16 v[16:19], v[104:107], v[56:59], v[16:19]
    v_mfma_f32_16x16x32_bf16 v[20:23], v[120:123], v[56:59], v[20:23]
    s_waitcnt lgkmcnt(0)
    v_mfma_f32_16x16x32_bf16 v[16:19], v[108:111], v[60:63], v[16:19]
    v_mfma_f32_16x16x32_bf16 v[20:23], v[124:127], v[60:63], v[20:23]
    v_cmp_eq_u32 vcc, 0, v1
    s_nop 6
    s_and_saveexec_b64 s[26:27], vcc
    ds_write_b128 v153, v[16:19]
    ds_write_b128 v153, v[20:23] offset:64
    s_mov_b64 exec, -1
    s_waitcnt lgkmcnt(0)
    s_barrier
    ds_read_b128 v[32:35], v154 offset:0
    ds_read_b128 v[48:51], v154 offset:64
    ds_read_b128 v[36:39], v154 offset:128
    ds_read_b128 v[52:55], v154 offset:192
    ds_read_b128 v[40:43], v154 offset:256
    ds_read_b128 v[56:59], v154 offset:320
    ds_read_b128 v[44:47], v154 offset:384
    ds_read_b128 v[60:63], v154 offset:448
    s_waitcnt lgkmcnt(0)
    v_pk_add_f32 v[32:33], v[32:33], v[36:37]
    v_pk_add_f32 v[40:41], v[40:41], v[44:45]
    v_pk_add_f32 v[34:35], v[34:35], v[38:39]
    v_pk_add_f32 v[42:43], v[42:43], v[46:47]
    v_pk_add_f32 v[48:49], v[48:49], v[52:53]
    v_pk_add_f32 v[56:57], v[56:57], v[60:61]
    v_pk_add_f32 v[50:51], v[50:51], v[54:55]
    v_pk_add_f32 v[58:59], v[58:59], v[62:63]
    v_pk_add_f32 v[32:33], v[32:33], v[40:41]
    v_pk_add_f32 v[34:35], v[34:35], v[42:43]
    v_pk_add_f32 v[48:49], v[48:49], v[56:57]
    v_pk_add_f32 v[50:51], v[50:51], v[58:59]
    v_cvt_pk_bf16_f32 v36, v32, v33
    v_cvt_pk_bf16_f32 v37, v34, v35
    v_cvt_pk_bf16_f32 v52, v48, v49
    v_cvt_pk_bf16_f32 v53, v50, v51
    v_lshlrev_b32 v32, 16, v36
    v_and_b32 v33, 0xffff0000, v36
    v_lshlrev_b32 v34, 16, v37
    v_and_b32 v35, 0xffff0000, v37
    v_lshlrev_b32 v48, 16, v52
    v_and_b32 v49, 0xffff0000, v52
    v_lshlrev_b32 v50, 16, v53
    v_and_b32 v51, 0xffff0000, v53
    v_pk_mul_f32 v[36:37], v[32:33], v[32:33]
    v_pk_mul_f32 v[38:39], v[34:35], v[34:35]
    v_pk_mul_f32 v[36:37], v[36:37], v[158:159] op_sel:[0,0] op_sel_hi:[1,0]
    v_pk_mul_f32 v[38:39], v[38:39], v[158:159] op_sel:[0,0] op_sel_hi:[1,0]
    v_pk_fma_f32 v[36:37], v[36:37], v[32:33], v[32:33]
    v_pk_fma_f32 v[38:39], v[38:39], v[34:35], v[34:35]
    v_pk_mul_f32 v[36:37], v[36:37], v[160:161] op_sel:[0,0] op_sel_hi:[1,0]
    v_pk_mul_f32 v[38:39], v[38:39], v[160:161] op_sel:[0,0] op_sel_hi:[1,0]
    v_exp_f32 v36, v36
    v_exp_f32 v37, v37
    v_exp_f32 v38, v38
    v_exp_f32 v39, v39
    s_nop 0
    v_pk_add_f32 v[36:37], v[36:37], v[162:163]
    v_pk_add_f32 v[38:39], v[38:39], v[162:163]
    v_rcp_f32 v36, v36
    v_rcp_f32 v37, v37
    v_rcp_f32 v38, v38
    v_rcp_f32 v39, v39
    s_nop 0
    v_pk_add_f32 v[36:37], v[162:163], v[36:37] neg_lo:[0,1] neg_hi:[0,1]
    v_pk_add_f32 v[38:39], v[162:163], v[38:39] neg_lo:[0,1] neg_hi:[0,1]
    v_pk_mul_f32 v[36:37], v[36:37], v[32:33]
    v_pk_mul_f32 v[38:39], v[38:39], v[34:35]
    v_cvt_pk_bf16_f32 v40, v36, v37
    v_cvt_pk_bf16_f32 v41, v38, v39
    v_lshlrev_b32 v36, 16, v40
    v_and_b32 v37, 0xffff0000, v40
    v_lshlrev_b32 v38, 16, v41
    v_and_b32 v39, 0xffff0000, v41
    v_pk_mul_f32 v[36:37], v[36:37], v[48:49]
    v_pk_mul_f32 v[38:39], v[38:39], v[50:51]
    v_cvt_pk_bf16_f32 v40, v36, v37
    v_cvt_pk_bf16_f32 v41, v38, v39
    v_cndmask_b32 v64, 0, v40, s[36:37]
    v_cndmask_b32 v65, 0, v41, s[36:37]
    v_cndmask_b32 v66, 0, v40, s[38:39]
    v_cndmask_b32 v67, 0, v41, s[38:39]
    v_cndmask_b32 v68, 0, v40, s[40:41]
    v_cndmask_b32 v69, 0, v41, s[40:41]
    v_cndmask_b32 v70, 0, v40, s[42:43]
    v_cndmask_b32 v71, 0, v41, s[42:43]
    v_cndmask_b32 v72, 0, v40, s[44:45]
    v_cndmask_b32 v73, 0, v41, s[44:45]
    v_cndmask_b32 v74, 0, v40, s[46:47]
    v_cndmask_b32 v75, 0, v41, s[46:47]
    v_cndmask_b32 v76, 0, v40, s[48:49]
    v_cndmask_b32 v77, 0, v41, s[48:49]
    v_cndmask_b32 v78, 0, v40, s[50:51]
    v_cndmask_b32 v79, 0, v41, s[50:51]
    s_nop 0
    v_mfma_f32_16x16x16_bf16 v[16:19], v[128:129], v[64:65], 0
    v_mfma_f32_16x16x16_bf16 v[20:23], v[130:131], v[66:67], 0
    v_mfma_f32_16x16x16_bf16 v[16:19], v[132:133], v[68:69], v[16:19]
    v_mfma_f32_16x16x16_bf16 v[20:23], v[134:135], v[70:71], v[20:23]
    v_mfma_f32_16x16x16_bf16 v[16:19], v[136:137], v[72:73], v[16:19]
    v_mfma_f32_16x16x16_bf16 v[20:23], v[138:139], v[74:75], v[20:23]
    v_mfma_f32_16x16x16_bf16 v[16:19], v[140:141], v[76:77], v[16:19]
    v_mfma_f32_16x16x16_bf16 v[20:23], v[142:143], v[78:79], v[20:23]
    v_cmp_gt_u32 vcc, 8, v1
    s_nop 6
    v_pk_add_f32 v[16:17], v[16:17], v[20:21]
    v_pk_add_f32 v[18:19], v[18:19], v[22:23]
    s_and_saveexec_b64 s[26:27], vcc
    buffer_store_dwordx4 v[16:19], v157, s[8:11], s31 offen sc1
    s_mov_b64 exec, -1
    s_cmp_lt_u32 s63, 32
    s_cbranch_scc0 L_fin
    s_cmp_eq_u32 s3, 0
    s_cbranch_scc0 L_fin
    ds_read_b128 v[92:95], v166
    s_mov_b64 s[72:73], -1
    s_mov_b64 s[74:75], -1
    s_mov_b64 s[76:77], -1
    s_mov_b64 s[78:79], -1
    s_mov_b64 s[80:81], -1
    s_mov_b64 s[82:83], -1
    s_mov_b64 s[84:85], -1
    s_mov_b32 s29, 131072
    buffer_load_dwordx4 v[32:35], v164, s[8:11], s52 offen sc1
    buffer_load_dwordx4 v[36:39], v164, s[8:11], s53 offen sc1
    buffer_load_dwordx4 v[40:43], v164, s[8:11], s56 offen sc1
    buffer_load_dwordx4 v[44:47], v164, s[8:11], s57 offen sc1
    buffer_load_dwordx4 v[48:51], v164, s[8:11], s61 offen sc1
    buffer_load_dwordx4 v[52:55], v164, s[8:11], s62 offen sc1
    buffer_load_dwordx4 v[56:59], v164, s[8:11], s64 offen sc1
L_h3poll:
    s_mov_b64 s[26:27], 0
    s_waitcnt vmcnt(6)
    v_max3_u32 v16, v32, v33, v34
    v_max_u32 v16, v16, v35
    v_cmp_eq_u32 vcc, -1, v16
    s_and_b64 s[72:73], s[72:73], vcc
    s_or_b64 s[26:27], s[26:27], s[72:73]
    s_mov_b64 exec, s[72:73]
    buffer_load_dwordx4 v[32:35], v164, s[8:11], s52 offen sc1
    s_mov_b64 exec, -1
    s_waitcnt vmcnt(6)
    v_max3_u32 v16, v36, v37, v38
    v_max_u32 v16, v16, v39
    v_cmp_eq_u32 vcc, -1, v16
    s_and_b64 s[74:75], s[74:75], vcc
    s_or_b64 s[26:27], s[26:27], s[74:75]
    s_mov_b64 exec, s[74:75]
    buffer_load_dwordx4 v[36:39], v164, s[8:11], s53 offen sc1
    s_mov_b64 exec, -1
    s_waitcnt vmcnt(6)
    v_max3_u32 v16, v40, v41, v42
    v_max_u32 v16, v16, v43
    v_cmp_eq_u32 vcc, -1, v16
    s_and_b64 s[76:77], s[76:77], vcc
    s_or_b64 s[26:27], s[26:27], s[76:77]
    s_mov_b64 exec, s[76:77]
    buffer_load_dwordx4 v[40:43], v164, s[8:11], s56 offen sc1
    s_mov_b64 exec, -1
    s_waitcnt vmcnt(6)
    v_max3_u32 v16, v44, v45, v46
    v_max_u32 v16, v16, v47
    v_cmp_eq_u32 vcc, -1, v16
    s_and_b64 s[78:79], s[78:79], vcc
    s_or_b64 s[26:27], s[26:27], s[78:79]
    s_mov_b64 exec, s[78:79]
    buffer_load_dwordx4 v[44:47], v164, s[8:11], s57 offen sc1
    s_mov_b64 exec, -1
    s_waitcnt vmcnt(6)
    v_max3_u32 v16, v48, v49, v50
    v_max_u32 v16, v16, v51
    v_cmp_eq_u32 vcc, -1, v16
    s_and_b64 s[80:81], s[80:81], vcc
    s_or_b64 s[26:27], s[26:27], s[80:81]
    s_mov_b64 exec, s[80:81]
    buffer_load_dwordx4 v[48:51], v164, s[8:11], s61 offen sc1
    s_mov_b64 exec, -1
    s_waitcnt vmcnt(6)
    v_max3_u32 v16, v52, v53, v54
    v_max_u32 v16, v16, v55
    v_cmp_eq_u32 vcc, -1, v16
    s_and_b64 s[82:83], s[82:83], vcc
    s_or_b64 s[26:27], s[26:27], s[82:83]
    s_mov_b64 exec, s[82:83]
    buffer_load_dwordx4 v[52:55], v164, s[8:11], s62 offen sc1
    s_mov_b64 exec, -1
    s_waitcnt vmcnt(6)
    v_max3_u32 v16, v56, v57, v58
    v_max_u32 v16, v16, v59
    v_cmp_eq_u32 vcc, -1, v16
    s_and_b64 s[84:85], s[84:85], vcc
    s_or_b64 s[26:27], s[26:27], s[84:85]
    s_mov_b64 exec, s[84:85]
    buffer_load_dwordx4 v[56:59], v164, s[8:11], s64 offen sc1
    s_mov_b64 exec, -1
    s_cmp_eq_u64 s[26:27], 0
    s_cbranch_scc1 L_h3got
    s_sub_u32 s29, s29, 1
    s_cmp_lg_u32 s29, 0
    s_cbranch_scc1 L_h3poll
    s_branch L_end
L_h3got:
    v_add_f32 v32, v32, v48
    v_add_f32 v33, v33, v49
    v_add_f32 v34, v34, v50
    v_add_f32 v35, v35, v51
    v_add_f32 v36, v36, v52
    v_add_f32 v37, v37, v53
    v_add_f32 v38, v38, v54
    v_add_f32 v39, v39, v55
    v_add_f32 v40, v40, v56
    v_add_f32 v41, v41, v57
    v_add_f32 v42, v42, v58
    v_add_f32 v43, v43, v59
    v_add_f32 v32, v32, v40
    v_add_f32 v33, v33, v41
    v_add_f32 v34, v34, v42
    v_add_f32 v35, v35, v43
    v_add_f32 v36, v36, v44
    v_add_f32 v37, v37, v45
    v_add_f32 v38, v38, v46
    v_add_f32 v39, v39, v47
    v_add_f32 v32, v32, v36
    v_add_f32 v33, v33, v37
    v_add_f32 v34, v34, v38
    v_add_f32 v35, v35, v39
    s_nop 0
    v_add_f32_dpp v32, v32, v32 row_ror:8 row_mask:0xf bank_mask:0xf
    v_add_f32_dpp v33, v33, v33 row_ror:8 row_mask:0xf bank_mask:0xf
    v_add_f32_dpp v34, v34, v34 row_ror:8 row_mask:0xf bank_mask:0xf
    v_add_f32_dpp v35, v35, v35 row_ror:8 row_mask:0xf bank_mask:0xf
    s_nop 0
    v_add_f32_dpp v32, v32, v32 row_ror:4 row_mask:0xf bank_mask:0xf
    v_add_f32_dpp v33, v33, v33 row_ror:4 row_mask:0xf bank_mask:0xf
    v_add_f32_dpp v34, v34, v34 row_ror:4 row_mask:0xf bank_mask:0xf
    v_add_f32_dpp v35, v35, v35 row_ror:4 row_mask:0xf bank_mask:0xf
    v_mov_b32 v40, v32
    v_mov_b32 v41, v33
    v_mov_b32 v42, v34
    v_mov_b32 v43, v35
    s_nop 0
    v_permlane16_swap_b32 v40, v32
    v_permlane16_swap_b32 v41, v33
    v_permlane16_swap_b32 v42, v34
    v_permlane16_swap_b32 v43, v35
    s_nop 0
    v_add_f32 v32, v40, v32
    v_add_f32 v33, v41, v33
    v_add_f32 v34, v42, v34
    v_add_f32 v35, v43, v35
    v_mov_b32 v40, v32
    v_mov_b32 v41, v33
    v_mov_b32 v42, v34
    v_mov_b32 v43, v35
    s_nop 0
    v_permlane32_swap_b32 v40, v32
    v_permlane32_swap_b32 v41, v33
    v_permlane32_swap_b32 v42, v34
    v_permlane32_swap_b32 v43, v35
    s_nop 0
    v_add_f32 v32, v40, v32
    v_add_f32 v33, v41, v33
    v_add_f32 v34, v42, v34
    v_add_f32 v35, v43, v35
    s_waitcnt lgkmcnt(0)
    v_cvt_pk_bf16_f32 v40, v32, v33
    v_cvt_pk_bf16_f32 v41, v34, v35
    v_lshlrev_b32 v32, 16, v40
    v_and_b32 v33, 0xffff0000, v40
    v_lshlrev_b32 v34, 16, v41
    v_and_b32 v35, 0xffff0000, v41
    v_add_f32 v32, v32, v92
    v_add_f32 v33, v33, v93
    v_add_f32 v34, v34, v94
    v_add_f32 v35, v35, v95
    v_cvt_pk_bf16_f32 v32, v32, v33
    v_cvt_pk_bf16_f32 v33, v34, v35
    s_mov_b64 exec, 0xf
    buffer_store_dwordx2 v[32:33], v167, s[12:15], s65 offen
L_fin:
L_end:
    s_endpgm
.section .rodata,"a"
.p2align 6
.amdhsa_kernel sequential_preLN__gqa_block_cached__glu_gated_geglu__decode_kernel
  .amdhsa_next_free_vgpr 200
  .amdhsa_next_free_sgpr 102
  .amdhsa_accum_offset 200
  .amdhsa_group_segment_fixed_size 0
  .amdhsa_kernarg_size 96
  .amdhsa_user_sgpr_count 2
  .amdhsa_user_sgpr_kernarg_segment_ptr 1
  .amdhsa_system_sgpr_workgroup_id_x 1
.end_amdhsa_kernel
```
